```python
import torch

def _softmax(x, axis=-1):
    return torch.softmax(x, dim=axis)
def _gelu(x):
    return torch.nn.functional.gelu(x, approximate="tanh")
def _silu(x):
    return torch.nn.functional.silu(x)
def _sigmoid(x):
    return torch.sigmoid(x)
def _layernorm(x, axis=-1, eps=1e-5):
    m = x.mean(dim=axis, keepdim=True)
    v = x.var(dim=axis, keepdim=True, unbiased=False)
    return (x - m) / torch.sqrt(v + eps)
def _scatter_add(tgt, idx, src, axis=0):
    return tgt.clone().index_add_(axis, idx, src)
def _segment_sum(src, seg, n):
    out = torch.zeros((n,) + src.shape[1:], dtype=src.dtype)
    return out.index_add_(0, seg, src)
def _pad(x, pw):
    flat = tuple(v for pair in reversed(pw) for v in pair)
    return torch.nn.functional.pad(x, flat)

kernel_name = 'concat_heads__ssm_conv_h3__grouped_kv_mqa__prompt'

def setup_inputs():

    _w = (lambda a: (lambda t: t.to(torch.bfloat16) if t.is_floating_point() else t)(torch.as_tensor(a)))
    def _A_setup():
        B, S, D = 1, 2048, 576
        ks = 4
        return {
            "q": _w((lambda *s: torch.randn(*s, dtype=torch.bfloat16) * 0.05)(B, S, D)),
            "k": _w((lambda *s: torch.randn(*s, dtype=torch.bfloat16) * 0.2)(B, S, D)),
            "v": _w((lambda *s: torch.randn(*s, dtype=torch.bfloat16) * 0.2)(B, S, D)),
            "shift_k": _w((lambda *s: torch.randn(*s, dtype=torch.bfloat16) * 0.2)(D, ks) * 0.5),
            "ssm_k": _w((lambda *s: torch.randn(*s, dtype=torch.bfloat16) * 0.8)(D, S) * (1.0 / S ** 0.5)),
            "ssm_D": _w((lambda *s: torch.randn(*s, dtype=torch.bfloat16) * 0.2)(D)),
        }
    _A_in = _A_setup()

    def _B_setup():
        B, S, D, H = 1, 2048, 576, 32
        Dh = D // H
        return {
            "x": _w((lambda *s: torch.randn(*s, dtype=torch.bfloat16) * 0.05)(B, S, D)),
            "wq": _w((lambda *s: torch.randn(*s, dtype=torch.bfloat16) * 0.8)(D, H * Dh)),
            "wk": _w((lambda *s: torch.randn(*s, dtype=torch.bfloat16) * 0.8)(D, Dh)),
            "wv": _w((lambda *s: torch.randn(*s, dtype=torch.bfloat16) * 0.05)(D, Dh)),
            "wo": _w((lambda *s: torch.randn(*s, dtype=torch.bfloat16) * 0.05)(H * Dh, D)),
        }
    _B_in = _B_setup()

    return {
        "A_q": _A_in["q"],
        "A_k": _A_in["k"],
        "A_v": _A_in["v"],
        "A_shift_k": _A_in["shift_k"],
        "A_ssm_k": _A_in["ssm_k"],
        "A_ssm_D": _A_in["ssm_D"],
        "B_x": _B_in["x"],
        "B_wq": _B_in["wq"],
        "B_wk": _B_in["wk"],
        "B_wv": _B_in["wv"],
        "B_wo": _B_in["wo"],
    }

def reference(A_q, A_k, A_v, A_shift_k, A_ssm_k, A_ssm_D, B_x, B_wq, B_wk, B_wv, B_wo):
    def _A_ref(q, k, v, shift_k, ssm_k, ssm_D):
        B, S, D = q.shape
        ks = shift_k.shape[-1]
        k_pad = _pad(k, ((0, 0), (ks - 1, 0), (0, 0)))
        k_shift = torch.zeros_like(k)
        for t in range(ks):
            k_shift = k_shift + k_pad[:, t:t + S, :] * shift_k[:, ks - 1 - t][None, None, :]
        kv = k_shift * v
        L = 2 * S
        kv_pad = _pad(kv, ((0, 0), (0, S), (0, 0)))
        kf_pad = _pad(ssm_k, ((0, 0), (0, S)))
        kv_f = (lambda x, axes=(-2,-1): torch.fft.rfft2(x.float(), dim=axes))(kv_pad[:, None, :, :], axes=(1, 2))
        kf_f = (lambda x, axes=(-2,-1): torch.fft.rfft2(x.float(), dim=axes))(kf_pad[:, None, :], axes=(1, 2))
        kf_f = (lambda x, *d: x.permute(*d))(kf_f, 1, 2, 0)
        y_f = kv_f * kf_f[None, :, :, :]
        y = (lambda x, s, axes=(-2,-1): torch.fft.irfft2(x, s=s, dim=axes).to(torch.bfloat16))(y_f, (1, L), axes=(1, 2))[:, 0, :S, :]
        y = y + kv * ssm_D[None, None, :]
        return q * y

    def _B_ref(x, wq, wk, wv, wo):
        B, S, D = x.shape
        H = 32
        Dh = D // H
        q = (lambda x, *d: x.permute(*d))((x @ wq).reshape(B, S, H, Dh), 0, 2, 1, 3)
        k = x @ wk
        v = x @ wv
        scores = torch.einsum("bhqd,bkd->bhqk", q, k) * (Dh ** -0.5)
        p = _softmax(scores, axis=-1)
        o = torch.einsum("bhqk,bkd->bhqd", p, v)
        return (lambda x, *d: x.permute(*d))(o, 0, 2, 1, 3).reshape(B, S, H * Dh) @ wo

    a = _A_ref(A_q, A_k, A_v, A_shift_k, A_ssm_k, A_ssm_D)
    b = _B_ref(B_x, B_wq, B_wk, B_wv, B_wo)
    return torch.concatenate([a, b], axis=-1)
```

```asm
; @launch grid=(256,1,1) block=(512,1,1) lds=163840
.amdgcn_target "amdgcn-amd-amdhsa--gfx950"
.text
.globl concat_heads__ssm_conv_h3__grouped_kv_mqa__prompt_kernel
.p2align 8
.type concat_heads__ssm_conv_h3__grouped_kv_mqa__prompt_kernel,@function
concat_heads__ssm_conv_h3__grouped_kv_mqa__prompt_kernel:
    s_cmp_ge_u32 s2, 256
    s_cbranch_scc1 L_end
    v_cmp_gt_u32 vcc, 16, v0
    s_getpc_b64 s[6:7]
L_pc:
    s_bfe_u32 s10, s2, 0x40003
    s_lshl_b32 s10, s10, 7
    s_and_saveexec_b64 s[8:9], vcc
    s_cbranch_execz L_noclr
    v_lshl_add_u32 v2, v0, 11, s10
    v_min_u32 v2, L_codeend-L_pc-4, v2
    global_load_dword v31, v2, s[6:7]
    v_lshlrev_b32 v3, 2, v0
    v_mov_b32 v4, 0
    v_add_u32 v3, 163776, v3
    ds_write_b32 v3, v4
    s_waitcnt lgkmcnt(0)
L_noclr:
    s_mov_b64 exec, s[8:9]
    s_load_dwordx2 s[40:41], s[0:1], 48
    s_bfe_u32 s6, s2, 65541
    s_lshl_b32 s6, s6, 3
    s_add_u32 s6, s6, 64
    s_load_dwordx2 s[48:49], s[0:1], s6
    s_load_dwordx2 s[44:45], s[0:1], 56
    s_load_dwordx2 s[68:69], s[0:1], 104
    s_load_dwordx2 s[64:65], s[0:1], 96
    s_load_dwordx2 s[56:57], s[0:1], 80
    s_load_dwordx2 s[32:33], s[0:1], 32
    s_load_dwordx2 s[36:37], s[0:1], 40
    s_load_dwordx2 s[60:61], s[0:1], 88
    v_lshrrev_b32 v2, 6, v0
    v_and_b32 v1, 63, v0
    s_and_b32 s6, s2, 7
    v_readfirstlane_b32 s3, v2
    s_lshl_b32 s6, s6, 2
    s_bfe_u32 s7, s2, 0x20003
    s_add_u32 s4, s6, s7
    s_lshr_b32 s5, s2, 5
    s_add_u32 s6, s4, s5
    s_mul_i32 s7, s6, 21846
    s_lshr_b32 s7, s7, 16
    s_mul_i32 s7, s7, 3
    s_sub_u32 s100, s6, s7
    s_mov_b32 s100, 0
    v_lshrrev_b32 v10, 4, v1
    v_bfe_u32 v11, v1, 2, 2
    v_and_b32 v12, 3, v1
    s_mov_b32 s42, 2359296
    s_mov_b32 s43, 0x20000
    s_barrier
    s_cmp_lt_u32 s3, 4
    s_cbranch_scc1 L_setup
    s_cmp_lt_u32 s3, 6
    s_cbranch_scc1 L_loader
    s_setprio 3
    s_sub_u32 s11, s3, 6
    s_lshr_b32 s10, s5, 1
    v_and_b32 v3, 7, v1
    v_xor_b32 v2, v10, v3
    v_lshlrev_b32 v2, 4, v2
    s_lshl_b32 s6, s4, 6
    s_lshl_b32 s7, s10, 4
    s_add_u32 s6, s6, s7
    v_lshrrev_b32 v3, 3, v1
    v_add_u32 v3, s6, v3
    v_mul_u32_u24 v3, 1152, v3
    v_add_u32 v4, v2, v3
    v_xor_b32 v6, 64, v4
    v_add_u32 v6, 9216, v6
    s_lshl_b32 s8, s11, 9
    s_lshl_b32 s9, s10, 11
    s_mul_i32 s6, s100, 3
    s_lshl_b32 s7, s11, 2
    s_sub_u32 s7, s7, s6
    s_add_u32 s7, s7, 9
    s_mov_b32 s21, s7
    s_add_u32 s22, s8, 640
    v_mul_u32_u24 v2, 21846, v1
    v_lshrrev_b32 v2, 16, v2
    v_mul_u32_u24 v2, 12, v2
    v_lshlrev_b32 v3, 4, v1
    v_sub_u32 v5, v3, v2
    s_mul_i32 s13, s11, 10368
    s_mul_i32 s12, s11, 14128
    s_add_u32 s12, s12, 130208
    s_mov_b32 s50, 20736
    s_mov_b32 s51, 0x20000
    s_waitcnt lgkmcnt(0)
L_kx:
    s_cmp_ge_u32 s21, 9
    s_cselect_b32 s6, 9, 0
    s_sub_u32 s21, s21, s6
    s_lshl_b32 s6, s21, 13
    s_add_u32 m0, s6, s9
    s_add_u32 s21, s21, 1
    buffer_load_dwordx4 v4, s[40:43], s8 offen  lds
    s_add_u32 m0, m0, 1024
    s_nop 0
    buffer_load_dwordx4 v6, s[40:43], s8 offen  lds
    s_add_u32 s8, s8, 128
    s_cmp_lt_u32 s8, s22
    s_cbranch_scc1 L_kx
    s_mov_b32 m0, s12
    s_add_u32 s22, s13, 10584
L_kw:
    buffer_load_dwordx4 v5, s[48:51], s13 offen lds
    s_add_u32 m0, m0, 1008
    s_add_u32 s13, s13, 756
    buffer_load_dwordx4 v5, s[48:51], s13 offen lds
    s_add_u32 m0, m0, 1008
    s_add_u32 s13, s13, 756
    s_cmp_lt_u32 s13, s22
    s_cbranch_scc1 L_kw
    s_cmp_ge_u32 s7, 9
    s_cselect_b32 s6, 9, 0
    s_sub_u32 s7, s7, s6
    s_lshl_b32 s6, s7, 13
    s_add_u32 s16, s6, s9
    s_add_u32 s7, s7, 1
    s_cmp_ge_u32 s7, 9
    s_cselect_b32 s6, 9, 0
    s_sub_u32 s7, s7, s6
    s_lshl_b32 s6, s7, 13
    s_add_u32 s17, s6, s9
    s_add_u32 s7, s7, 1
    s_cmp_ge_u32 s7, 9
    s_cselect_b32 s6, 9, 0
    s_sub_u32 s7, s7, s6
    s_lshl_b32 s6, s7, 13
    s_add_u32 s18, s6, s9
    s_add_u32 s7, s7, 1
    s_cmp_ge_u32 s7, 9
    s_cselect_b32 s6, 9, 0
    s_sub_u32 s7, s7, s6
    s_lshl_b32 s6, s7, 13
    s_add_u32 s19, s6, s9
    s_add_u32 s7, s7, 1
    s_cmp_ge_u32 s7, 9
    s_cselect_b32 s6, 9, 0
    s_sub_u32 s7, s7, s6
    s_lshl_b32 s6, s7, 13
    s_add_u32 s20, s6, s9
    s_add_u32 s7, s7, 1
    s_mov_b32 s70, 16777216
    s_mov_b32 s71, 0x20000
    v_mov_b32 v212, 0
    v_lshl_add_u32 v2, v10, 3, v11
    v_mul_u32_u24 v2, 48, v2
    v_lshl_add_u32 v2, v12, 3, v2
    v_add_u32 v15, s12, v2
    v_and_b32 v2, 15, v1
    v_lshlrev_b32 v3, 7, v2
    v_bfe_u32 v7, v2, 1, 3
    v_xor_b32 v7, v7, v10
    s_lshl_b32 s6, s11, 2
    v_xor_b32 v7, s6, v7
    v_lshl_add_u32 v13, v7, 4, v3
    v_xor_b32 v7, 4, v7
    v_lshl_add_u32 v14, v7, 4, v3
    s_cmp_eq_u32 s11, 0
    v_add_u32 v32, s16, v13
    s_cselect_b32 s6, s16, s17
    v_add_u32 v36, s6, v14
    v_add_u32 v40, s17, v13
    s_cselect_b32 s6, s17, s18
    v_add_u32 v44, s6, v14
    v_add_u32 v48, s18, v13
    s_cselect_b32 s6, s18, s19
    v_add_u32 v52, s6, v14
    v_add_u32 v56, s19, v13
    s_cselect_b32 s6, s19, s20
    v_add_u32 v60, s6, v14
    v_add_u32 v64, s20, v13
    s_lshl_b32 s9, s4, 2
    s_add_u32 s9, s9, s10
    s_lshr_b32 s13, s9, 6
    s_mul_i32 s13, s13, 18432
    s_bfe_u32 s6, s9, 0x20004
    s_mul_i32 s6, s6, 36864
    s_add_u32 s13, s13, s6
    s_and_b32 s9, s9, 15
    v_lshl_add_u32 v8, v1, 4, s12
    s_xor_b32 s6, s11, 1
    s_mul_i32 s6, s6, 14128
    s_add_u32 s6, s6, 130208
    v_lshl_add_u32 v9, v1, 4, s6
    v_and_b32 v16, 15, v1
    v_lshrrev_b32 v17, 1, v10
    v_and_b32 v18, 1, v10
    s_bitcmp1_b32 s5, 0
    s_cbranch_scc1 L_vad
    s_lshr_b32 s6, s9, 1
    s_and_b32 s7, s9, 1
    s_lshl_b32 s7, s7, 8
    v_lshl_add_u32 v20, v16, 4, s7
    v_lshl_add_u32 v19, v17, 9, v20
    v_lshl_add_u32 v19, v18, 3, v19
    s_lshl_b32 s8, s6, 10
    s_add_u32 s8, s8, s13
    s_lshr_b32 s7, s6, 2
    s_lshl_b32 s7, s7, 9
    s_and_b32 s6, s6, 3
    s_lshl_b32 s6, s6, 2
    s_add_u32 s9, s6, s7
    s_add_u32 s9, s9, s13
    s_add_u32 s9, s9, 8192
    s_branch L_kad
L_vad:
    s_mul_i32 s8, s9, 576
    s_add_u32 s8, s8, s13
    s_add_u32 s8, s8, 9216
    v_mul_u32_u24 v3, 288, v17
    v_lshl_add_u32 v19, v16, 4, v3
    v_lshl_add_u32 v19, v18, 3, v19
    v_mov_b32 v20, v19
L_kad:
    v_mov_b32 v21, 163776
    v_mov_b32 v22, 1
    s_waitcnt vmcnt(0)
    s_bitcmp1_b32 s5, 0
    s_cbranch_scc1 L_vg
    ds_read_b128 v[32:35], v32
    ds_read_b64_tr_b16 v[104:105], v15 offset:0
    ds_read_b64_tr_b16 v[106:107], v15 offset:192
    ds_read_b64_tr_b16 v[108:109], v15 offset:32
    ds_read_b64_tr_b16 v[110:111], v15 offset:224
    ds_read_b128 v[36:39], v36
    ds_read_b64_tr_b16 v[112:113], v15 offset:1536
    ds_read_b64_tr_b16 v[114:115], v15 offset:1728
    ds_read_b64_tr_b16 v[116:117], v15 offset:1568
    ds_read_b64_tr_b16 v[118:119], v15 offset:1760
    ds_read_b128 v[40:43], v40
    ds_read_b64_tr_b16 v[120:121], v15 offset:3072
    ds_read_b64_tr_b16 v[122:123], v15 offset:3264
    ds_read_b64_tr_b16 v[124:125], v15 offset:3104
    ds_read_b64_tr_b16 v[126:127], v15 offset:3296
    s_waitcnt lgkmcnt(10)
    ds_read_b128 v[44:47], v44
    ds_read_b64_tr_b16 v[128:129], v15 offset:4608
    ds_read_b64_tr_b16 v[130:131], v15 offset:4800
    ds_read_b64_tr_b16 v[132:133], v15 offset:4640
    ds_read_b64_tr_b16 v[134:135], v15 offset:4832
    v_mfma_f32_16x16x32_bf16 v[176:179], v[104:107], v[32:35], 0
    v_mfma_f32_16x16x32_bf16 v[180:183], v[108:111], v[32:35], 0
    s_waitcnt lgkmcnt(10)
    ds_read_b128 v[48:51], v48
    ds_read_b64_tr_b16 v[136:137], v15 offset:6144
    ds_read_b64_tr_b16 v[138:139], v15 offset:6336
    ds_read_b64_tr_b16 v[140:141], v15 offset:6176
    ds_read_b64_tr_b16 v[142:143], v15 offset:6368
    v_mfma_f32_16x16x32_bf16 v[176:179], v[112:115], v[36:39], v[176:179]
    v_mfma_f32_16x16x32_bf16 v[180:183], v[116:119], v[36:39], v[180:183]
    s_waitcnt lgkmcnt(10)
    ds_read_b128 v[52:55], v52
    ds_read_b64_tr_b16 v[144:145], v15 offset:7680
    ds_read_b64_tr_b16 v[146:147], v15 offset:7872
    ds_read_b64_tr_b16 v[148:149], v15 offset:7712
    ds_read_b64_tr_b16 v[150:151], v15 offset:7904
    v_mfma_f32_16x16x32_bf16 v[176:179], v[120:123], v[40:43], v[176:179]
    v_mfma_f32_16x16x32_bf16 v[180:183], v[124:127], v[40:43], v[180:183]
    s_waitcnt lgkmcnt(10)
    ds_read_b128 v[56:59], v56
    ds_read_b64_tr_b16 v[152:153], v15 offset:9216
    ds_read_b64_tr_b16 v[154:155], v15 offset:9408
    ds_read_b64_tr_b16 v[156:157], v15 offset:9248
    ds_read_b64_tr_b16 v[158:159], v15 offset:9440
    v_mfma_f32_16x16x32_bf16 v[176:179], v[128:131], v[44:47], v[176:179]
    v_mfma_f32_16x16x32_bf16 v[180:183], v[132:135], v[44:47], v[180:183]
    s_waitcnt lgkmcnt(10)
    ds_read_b128 v[60:63], v60
    ds_read_b64_tr_b16 v[160:161], v15 offset:10752
    ds_read_b64_tr_b16 v[162:163], v15 offset:10944
    ds_read_b64_tr_b16 v[164:165], v15 offset:10784
    ds_read_b64_tr_b16 v[166:167], v15 offset:10976
    v_mfma_f32_16x16x32_bf16 v[176:179], v[136:139], v[48:51], v[176:179]
    v_mfma_f32_16x16x32_bf16 v[180:183], v[140:143], v[48:51], v[180:183]
    s_waitcnt lgkmcnt(10)
    ds_read_b128 v[64:67], v64
    ds_read_b64_tr_b16 v[168:169], v15 offset:12288
    ds_read_b64_tr_b16 v[170:171], v15 offset:12480
    ds_read_b64_tr_b16 v[172:173], v15 offset:12320
    ds_read_b64_tr_b16 v[174:175], v15 offset:12512
    v_mfma_f32_16x16x32_bf16 v[176:179], v[144:147], v[52:55], v[176:179]
    v_mfma_f32_16x16x32_bf16 v[180:183], v[148:151], v[52:55], v[180:183]
    s_waitcnt lgkmcnt(10)
    v_mfma_f32_16x16x32_bf16 v[176:179], v[152:155], v[56:59], v[176:179]
    v_mfma_f32_16x16x32_bf16 v[180:183], v[156:159], v[56:59], v[180:183]
    s_waitcnt lgkmcnt(5)
    v_mfma_f32_16x16x32_bf16 v[176:179], v[160:163], v[60:63], v[176:179]
    v_mfma_f32_16x16x32_bf16 v[180:183], v[164:167], v[60:63], v[180:183]
    s_waitcnt lgkmcnt(0)
    v_mfma_f32_16x16x32_bf16 v[176:179], v[168:171], v[64:67], v[176:179]
    v_mfma_f32_16x16x32_bf16 v[180:183], v[172:175], v[64:67], v[180:183]
    s_branch L_kvg
L_vg:
    ds_read_b128 v[32:35], v32
    ds_read_b64_tr_b16 v[104:105], v15 offset:0
    ds_read_b64_tr_b16 v[106:107], v15 offset:192
    ds_read_b64_tr_b16 v[108:109], v15 offset:32
    ds_read_b64_tr_b16 v[110:111], v15 offset:224
    ds_read_b128 v[36:39], v36
    ds_read_b64_tr_b16 v[112:113], v15 offset:1536
    ds_read_b64_tr_b16 v[114:115], v15 offset:1728
    ds_read_b64_tr_b16 v[116:117], v15 offset:1568
    ds_read_b64_tr_b16 v[118:119], v15 offset:1760
    ds_read_b128 v[40:43], v40
    ds_read_b64_tr_b16 v[120:121], v15 offset:3072
    ds_read_b64_tr_b16 v[122:123], v15 offset:3264
    ds_read_b64_tr_b16 v[124:125], v15 offset:3104
    ds_read_b64_tr_b16 v[126:127], v15 offset:3296
    s_waitcnt lgkmcnt(10)
    ds_read_b128 v[44:47], v44
    ds_read_b64_tr_b16 v[128:129], v15 offset:4608
    ds_read_b64_tr_b16 v[130:131], v15 offset:4800
    ds_read_b64_tr_b16 v[132:133], v15 offset:4640
    ds_read_b64_tr_b16 v[134:135], v15 offset:4832
    v_mfma_f32_16x16x32_bf16 v[176:179], v[32:35], v[104:107], 0
    v_mfma_f32_16x16x32_bf16 v[180:183], v[32:35], v[108:111], 0
    s_waitcnt lgkmcnt(10)
    ds_read_b128 v[48:51], v48
    ds_read_b64_tr_b16 v[136:137], v15 offset:6144
    ds_read_b64_tr_b16 v[138:139], v15 offset:6336
    ds_read_b64_tr_b16 v[140:141], v15 offset:6176
    ds_read_b64_tr_b16 v[142:143], v15 offset:6368
    v_mfma_f32_16x16x32_bf16 v[176:179], v[36:39], v[112:115], v[176:179]
    v_mfma_f32_16x16x32_bf16 v[180:183], v[36:39], v[116:119], v[180:183]
    s_waitcnt lgkmcnt(10)
    ds_read_b128 v[52:55], v52
    ds_read_b64_tr_b16 v[144:145], v15 offset:7680
    ds_read_b64_tr_b16 v[146:147], v15 offset:7872
    ds_read_b64_tr_b16 v[148:149], v15 offset:7712
    ds_read_b64_tr_b16 v[150:151], v15 offset:7904
    v_mfma_f32_16x16x32_bf16 v[176:179], v[40:43], v[120:123], v[176:179]
    v_mfma_f32_16x16x32_bf16 v[180:183], v[40:43], v[124:127], v[180:183]
    s_waitcnt lgkmcnt(10)
    ds_read_b128 v[56:59], v56
    ds_read_b64_tr_b16 v[152:153], v15 offset:9216
    ds_read_b64_tr_b16 v[154:155], v15 offset:9408
    ds_read_b64_tr_b16 v[156:157], v15 offset:9248
    ds_read_b64_tr_b16 v[158:159], v15 offset:9440
    v_mfma_f32_16x16x32_bf16 v[176:179], v[44:47], v[128:131], v[176:179]
    v_mfma_f32_16x16x32_bf16 v[180:183], v[44:47], v[132:135], v[180:183]
    s_waitcnt lgkmcnt(10)
    ds_read_b128 v[60:63], v60
    ds_read_b64_tr_b16 v[160:161], v15 offset:10752
    ds_read_b64_tr_b16 v[162:163], v15 offset:10944
    ds_read_b64_tr_b16 v[164:165], v15 offset:10784
    ds_read_b64_tr_b16 v[166:167], v15 offset:10976
    v_mfma_f32_16x16x32_bf16 v[176:179], v[48:51], v[136:139], v[176:179]
    v_mfma_f32_16x16x32_bf16 v[180:183], v[48:51], v[140:143], v[180:183]
    s_waitcnt lgkmcnt(10)
    ds_read_b128 v[64:67], v64
    ds_read_b64_tr_b16 v[168:169], v15 offset:12288
    ds_read_b64_tr_b16 v[170:171], v15 offset:12480
    ds_read_b64_tr_b16 v[172:173], v15 offset:12320
    ds_read_b64_tr_b16 v[174:175], v15 offset:12512
    v_mfma_f32_16x16x32_bf16 v[176:179], v[52:55], v[144:147], v[176:179]
    v_mfma_f32_16x16x32_bf16 v[180:183], v[52:55], v[148:151], v[180:183]
    s_waitcnt lgkmcnt(10)
    v_mfma_f32_16x16x32_bf16 v[176:179], v[56:59], v[152:155], v[176:179]
    v_mfma_f32_16x16x32_bf16 v[180:183], v[56:59], v[156:159], v[180:183]
    s_waitcnt lgkmcnt(5)
    v_mfma_f32_16x16x32_bf16 v[176:179], v[60:63], v[160:163], v[176:179]
    v_mfma_f32_16x16x32_bf16 v[180:183], v[60:63], v[164:167], v[180:183]
    s_waitcnt lgkmcnt(0)
    v_mfma_f32_16x16x32_bf16 v[176:179], v[64:67], v[168:171], v[176:179]
    v_mfma_f32_16x16x32_bf16 v[180:183], v[64:67], v[172:175], v[180:183]
L_kvg:
    s_nop 6
    ds_write_b128 v8, v[176:179]
    ds_write_b128 v8, v[180:183] offset:1024
    s_mov_b64 exec, 1
    ds_add_rtn_u32 v7, v21, v22
    s_mov_b64 exec, -1
    ds_read_b128 v[184:187], v9
    ds_read_b128 v[188:191], v9 offset:1024
    s_waitcnt lgkmcnt(0)
    v_readfirstlane_b32 s78, v7
    s_nop 0
    s_cmp_eq_u32 s78, 1
    s_cbranch_scc0 L_kvfirst
    s_mov_b64 exec, 1
    ds_add_u32 v21, v22 offset:8
    ds_add_u32 v21, v22 offset:4
    s_mov_b64 exec, -1
    v_add_f32 v176, v176, v184
    v_add_f32 v177, v177, v185
    v_add_f32 v178, v178, v186
    v_add_f32 v179, v179, v187
    v_add_f32 v180, v180, v188
    v_add_f32 v181, v181, v189
    v_add_f32 v182, v182, v190
    v_add_f32 v183, v183, v191
    v_cvt_pk_bf16_f32 v184, v176, v177
    v_cvt_pk_bf16_f32 v185, v178, v179
    v_cvt_pk_bf16_f32 v186, v180, v181
    v_cvt_pk_bf16_f32 v187, v182, v183
    buffer_store_dwordx2 v[184:185], v19, s[68:71], s8 offen sc1
    s_bitcmp1_b32 s5, 0
    s_cbranch_scc1 L_vst
    s_mov_b64 exec, 0xffff
    buffer_store_dword v186, v20, s[68:71], s9 offen sc1
    s_branch L_kvst
L_vst:
    s_mov_b32 exec_lo, 0x00030003
    s_mov_b32 exec_hi, 0x00030003
    buffer_store_dwordx2 v[186:187], v19, s[68:71], s8 offen offset:256 sc1
L_kvst:
    s_mov_b64 exec, -1
L_kvfirst:
    s_branch L_setup
L_ret_k:
    s_sub_u32 s11, s3, 6
    s_lshl_b32 s6, s11, 5
    v_and_b32 v2, 15, v1
    v_add_u32 v2, s6, v2
    v_lshlrev_b32 v3, 7, v2
    v_bfe_u32 v7, v2, 1, 3
    v_xor_b32 v7, v7, v10
    v_lshl_add_u32 v16, v7, 4, v3
    v_xor_b32 v7, 4, v7
    v_lshl_add_u32 v17, v7, 4, v3
    v_mul_u32_u24 v9, 208, v2
    v_lshl_add_u32 v9, v10, 3, v9
    v_add_u32 v9, 147620, v9
    v_lshl_add_u32 v2, v10, 3, v11
    v_mul_u32_u24 v2, 144, v2
    v_lshl_add_u32 v2, v12, 3, v2
    v_add_u32 v18, 73856, v2
    v_mov_b32 v7, 163784
    s_mov_b32 s83, 200000
L_lw_1:
    ds_read_b32 v2, v7
    s_waitcnt lgkmcnt(0)
    v_readfirstlane_b32 s6, v2
    s_nop 0
    s_cmp_ge_u32 s6, 3
    s_cbranch_scc1 L_lw_1d
    s_sleep 1
    s_sub_u32 s83, s83, 1
    s_cmp_lg_u32 s83, 0
    s_cbranch_scc1 L_lw_1
L_lw_1d:
    ds_read_b128 v[32:35], v16 offset:0
    ds_read_b128 v[36:39], v16 offset:2048
    ds_read_b64_tr_b16 v[208:209], v18 offset:0
    ds_read_b64_tr_b16 v[210:211], v18 offset:576
    ds_read_b128 v[40:43], v17 offset:0
    ds_read_b128 v[44:47], v17 offset:2048
    ds_read_b64_tr_b16 v[212:213], v18 offset:4608
    ds_read_b64_tr_b16 v[214:215], v18 offset:5184
    ds_read_b128 v[48:51], v16 offset:8192
    ds_read_b128 v[52:55], v16 offset:10240
    ds_read_b64_tr_b16 v[216:217], v18 offset:9216
    ds_read_b64_tr_b16 v[218:219], v18 offset:9792
    s_waitcnt lgkmcnt(8)
    ds_read_b128 v[56:59], v17 offset:8192
    ds_read_b128 v[60:63], v17 offset:10240
    ds_read_b64_tr_b16 v[220:221], v18 offset:13824
    ds_read_b64_tr_b16 v[222:223], v18 offset:14400
    v_mfma_f32_16x16x32_bf16 v[176:179], v[208:211], v[32:35], 0
    v_mfma_f32_16x16x32_bf16 v[180:183], v[208:211], v[36:39], 0
    s_waitcnt lgkmcnt(8)
    ds_read_b128 v[64:67], v16 offset:16384
    ds_read_b128 v[68:71], v16 offset:18432
    ds_read_b64_tr_b16 v[224:225], v18 offset:18432
    ds_read_b64_tr_b16 v[226:227], v18 offset:19008
    v_mfma_f32_16x16x32_bf16 v[176:179], v[212:215], v[40:43], v[176:179]
    v_mfma_f32_16x16x32_bf16 v[180:183], v[212:215], v[44:47], v[180:183]
    s_waitcnt lgkmcnt(8)
    ds_read_b128 v[72:75], v17 offset:16384
    ds_read_b128 v[76:79], v17 offset:18432
    ds_read_b64_tr_b16 v[228:229], v18 offset:23040
    ds_read_b64_tr_b16 v[230:231], v18 offset:23616
    v_mfma_f32_16x16x32_bf16 v[176:179], v[216:219], v[48:51], v[176:179]
    v_mfma_f32_16x16x32_bf16 v[180:183], v[216:219], v[52:55], v[180:183]
    s_waitcnt lgkmcnt(8)
    v_mfma_f32_16x16x32_bf16 v[176:179], v[220:223], v[56:59], v[176:179]
    v_mfma_f32_16x16x32_bf16 v[180:183], v[220:223], v[60:63], v[180:183]
    s_waitcnt lgkmcnt(4)
    v_mfma_f32_16x16x32_bf16 v[176:179], v[224:227], v[64:67], v[176:179]
    v_mfma_f32_16x16x32_bf16 v[180:183], v[224:227], v[68:71], v[180:183]
    s_waitcnt lgkmcnt(0)
    v_mfma_f32_16x16x32_bf16 v[176:179], v[228:231], v[72:75], v[176:179]
    v_mfma_f32_16x16x32_bf16 v[180:183], v[228:231], v[76:79], v[180:183]
    v_add_u32 v16, 24576, v16
    v_add_u32 v17, 24576, v17
    v_add_u32 v18, 56480, v18
    v_mov_b32 v7, 163788
    s_mov_b32 s83, 200000
L_lw_2:
    ds_read_b32 v2, v7
    s_waitcnt lgkmcnt(0)
    v_readfirstlane_b32 s6, v2
    s_nop 0
    s_cmp_ge_u32 s6, 6
    s_cbranch_scc1 L_lw_2d
    s_sleep 1
    s_sub_u32 s83, s83, 1
    s_cmp_lg_u32 s83, 0
    s_cbranch_scc1 L_lw_2
L_lw_2d:
    ds_read_b128 v[32:35], v16 offset:0
    ds_read_b128 v[36:39], v16 offset:2048
    ds_read_b64_tr_b16 v[208:209], v18 offset:0
    ds_read_b64_tr_b16 v[210:211], v18 offset:576
    ds_read_b128 v[40:43], v17 offset:0
    ds_read_b128 v[44:47], v17 offset:2048
    ds_read_b64_tr_b16 v[212:213], v18 offset:4608
    ds_read_b64_tr_b16 v[214:215], v18 offset:5184
    ds_read_b128 v[48:51], v16 offset:8192
    ds_read_b128 v[52:55], v16 offset:10240
    ds_read_b64_tr_b16 v[216:217], v18 offset:9216
    ds_read_b64_tr_b16 v[218:219], v18 offset:9792
    s_waitcnt lgkmcnt(8)
    ds_read_b128 v[56:59], v17 offset:8192
    ds_read_b128 v[60:63], v17 offset:10240
    ds_read_b64_tr_b16 v[220:221], v18 offset:13824
    ds_read_b64_tr_b16 v[222:223], v18 offset:14400
    v_mfma_f32_16x16x32_bf16 v[176:179], v[208:211], v[32:35], v[176:179]
    v_mfma_f32_16x16x32_bf16 v[180:183], v[208:211], v[36:39], v[180:183]
    s_waitcnt lgkmcnt(8)
    ds_read_b128 v[64:67], v16 offset:16384
    ds_read_b128 v[68:71], v16 offset:18432
    ds_read_b64_tr_b16 v[224:225], v18 offset:18432
    ds_read_b64_tr_b16 v[226:227], v18 offset:19008
    v_mfma_f32_16x16x32_bf16 v[176:179], v[212:215], v[40:43], v[176:179]
    v_mfma_f32_16x16x32_bf16 v[180:183], v[212:215], v[44:47], v[180:183]
    s_waitcnt lgkmcnt(8)
    ds_read_b128 v[72:75], v17 offset:16384
    ds_read_b128 v[76:79], v17 offset:18432
    ds_read_b64_tr_b16 v[228:229], v18 offset:23040
    ds_read_b64_tr_b16 v[230:231], v18 offset:23616
    v_mfma_f32_16x16x32_bf16 v[176:179], v[216:219], v[48:51], v[176:179]
    v_mfma_f32_16x16x32_bf16 v[180:183], v[216:219], v[52:55], v[180:183]
    s_waitcnt lgkmcnt(8)
    v_mfma_f32_16x16x32_bf16 v[176:179], v[220:223], v[56:59], v[176:179]
    v_mfma_f32_16x16x32_bf16 v[180:183], v[220:223], v[60:63], v[180:183]
    s_waitcnt lgkmcnt(4)
    v_mfma_f32_16x16x32_bf16 v[176:179], v[224:227], v[64:67], v[176:179]
    v_mfma_f32_16x16x32_bf16 v[180:183], v[224:227], v[68:71], v[180:183]
    s_waitcnt lgkmcnt(0)
    v_mfma_f32_16x16x32_bf16 v[176:179], v[228:231], v[72:75], v[176:179]
    v_mfma_f32_16x16x32_bf16 v[180:183], v[228:231], v[76:79], v[180:183]
    ds_add_u32 v5, v13 offset:20
    v_add_u32 v16, 24576, v16
    v_add_u32 v17, 24576, v17
    v_add_u32 v18, 4294939056, v18
    v_mov_b32 v7, 163792
    s_mov_b32 s83, 200000
L_lw_3:
    ds_read_b32 v2, v7
    s_waitcnt lgkmcnt(0)
    v_readfirstlane_b32 s6, v2
    s_nop 0
    s_cmp_ge_u32 s6, 2
    s_cbranch_scc1 L_lw_3d
    s_sleep 1
    s_sub_u32 s83, s83, 1
    s_cmp_lg_u32 s83, 0
    s_cbranch_scc1 L_lw_3
L_lw_3d:
    ds_read_b128 v[32:35], v16 offset:0
    ds_read_b128 v[36:39], v16 offset:2048
    ds_read_b64_tr_b16 v[208:209], v18 offset:0
    ds_read_b64_tr_b16 v[210:211], v18 offset:576
    ds_read_b128 v[40:43], v17 offset:0
    ds_read_b128 v[44:47], v17 offset:2048
    ds_read_b64_tr_b16 v[212:213], v18 offset:4608
    ds_read_b64_tr_b16 v[214:215], v18 offset:5184
    ds_read_b128 v[48:51], v16 offset:8192
    ds_read_b128 v[52:55], v16 offset:10240
    ds_read_b64_tr_b16 v[216:217], v18 offset:9216
    ds_read_b64_tr_b16 v[218:219], v18 offset:9792
    s_waitcnt lgkmcnt(8)
    ds_read_b128 v[56:59], v17 offset:8192
    ds_read_b128 v[60:63], v17 offset:10240
    ds_read_b64_tr_b16 v[220:221], v18 offset:13824
    ds_read_b64_tr_b16 v[222:223], v18 offset:14400
    v_mfma_f32_16x16x32_bf16 v[176:179], v[208:211], v[32:35], v[176:179]
    v_mfma_f32_16x16x32_bf16 v[180:183], v[208:211], v[36:39], v[180:183]
    s_waitcnt lgkmcnt(8)
    ds_read_b128 v[64:67], v16 offset:16384
    ds_read_b128 v[68:71], v16 offset:18432
    ds_read_b64_tr_b16 v[224:225], v18 offset:18432
    ds_read_b64_tr_b16 v[226:227], v18 offset:19008
    v_mfma_f32_16x16x32_bf16 v[176:179], v[212:215], v[40:43], v[176:179]
    v_mfma_f32_16x16x32_bf16 v[180:183], v[212:215], v[44:47], v[180:183]
    s_waitcnt lgkmcnt(8)
    ds_read_b128 v[72:75], v17 offset:16384
    ds_read_b128 v[76:79], v17 offset:18432
    ds_read_b64_tr_b16 v[228:229], v18 offset:23040
    ds_read_b64_tr_b16 v[230:231], v18 offset:23616
    v_mfma_f32_16x16x32_bf16 v[176:179], v[216:219], v[48:51], v[176:179]
    v_mfma_f32_16x16x32_bf16 v[180:183], v[216:219], v[52:55], v[180:183]
    s_waitcnt lgkmcnt(8)
    v_mfma_f32_16x16x32_bf16 v[176:179], v[220:223], v[56:59], v[176:179]
    v_mfma_f32_16x16x32_bf16 v[180:183], v[220:223], v[60:63], v[180:183]
    s_waitcnt lgkmcnt(4)
    v_mfma_f32_16x16x32_bf16 v[176:179], v[224:227], v[64:67], v[176:179]
    v_mfma_f32_16x16x32_bf16 v[180:183], v[224:227], v[68:71], v[180:183]
    s_waitcnt lgkmcnt(0)
    v_mfma_f32_16x16x32_bf16 v[176:179], v[228:231], v[72:75], v[176:179]
    v_mfma_f32_16x16x32_bf16 v[180:183], v[228:231], v[76:79], v[180:183]
    v_mov_b32 v7, 163796
    s_mov_b32 s83, 200000
L_lw_4:
    ds_read_b32 v2, v7
    s_waitcnt lgkmcnt(0)
    v_readfirstlane_b32 s6, v2
    s_nop 0
    s_and_b32 s7, s6, 255
    s_cmp_ge_u32 s7, 6
    s_cbranch_scc1 L_lw_4d
    s_sleep 1
    s_sub_u32 s83, s83, 1
    s_cmp_lg_u32 s83, 0
    s_cbranch_scc1 L_lw_4
L_lw_4d:
    s_branch L_dma0
L_ret4_k:
    s_mov_b32 s6, 1051597459
    v_mul_f32 v176, s6, v176
    v_mul_f32 v177, s6, v177
    v_mul_f32 v178, s6, v178
    v_mul_f32 v179, s6, v179
    v_mul_f32 v180, s6, v180
    v_mul_f32 v181, s6, v181
    v_mul_f32 v182, s6, v182
    v_mul_f32 v183, s6, v183
    v_cvt_pk_bf16_f32 v184, v176, v177
    v_cvt_pk_bf16_f32 v185, v178, v179
    v_cvt_pk_bf16_f32 v186, v180, v181
    v_cvt_pk_bf16_f32 v187, v182, v183
    s_mov_b32 exec_hi, 0
    ds_write_b32 v9, v184
    ds_write_b32 v9, v185 offset:4
    ds_write_b32 v9, v186 offset:3328
    ds_write_b32 v9, v187 offset:3332
    s_mov_b64 exec, -1
    s_branch L_qdone
L_loader:
    s_and_b32 s11, s3, 1
    v_and_b32 v3, 7, v1
    v_xor_b32 v2, v10, v3
    v_lshlrev_b32 v2, 4, v2
    s_lshl_b32 s6, s4, 6
    v_lshrrev_b32 v3, 3, v1
    v_add_u32 v3, s6, v3
    v_mul_u32_u24 v3, 1152, v3
    v_add_u32 v26, v2, v3
    s_lshl_b32 s6, s11, 6
    v_xor_b32 v26, s6, v26
    v_mul_u32_u24 v2, 7282, v1
    v_lshrrev_b32 v2, 16, v2
    v_mul_u32_u24 v2, 1008, v2
    v_lshlrev_b32 v3, 4, v1
    s_mul_i32 s6, s5, 144
    v_add3_u32 v27, v3, v2, s6
    s_mul_i32 s8, s11, 9216
    s_lshl_b32 s9, s11, 10
    s_and_b32 s6, s3, 3
    s_mul_i32 s12, s6, 8064
    s_mul_i32 s13, s6, 1008
    s_add_u32 s13, s13, 73728
    v_add_u32 v28, s13, v3
    v_add_u32 v28, 56480, v28
    s_lshr_b32 s10, s5, 1
    s_add_u32 s6, s10, 1
    s_and_b32 s6, s6, 3
    s_mul_i32 s7, s6, 18432
    s_add_u32 s72, s7, s8
    s_lshl_b32 s7, s6, 11
    s_add_u32 s78, s7, s9
    s_add_u32 s6, s10, 2
    s_and_b32 s6, s6, 3
    s_mul_i32 s7, s6, 18432
    s_add_u32 s73, s7, s8
    s_lshl_b32 s7, s6, 11
    s_add_u32 s79, s7, s9
    s_add_u32 s6, s10, 3
    s_and_b32 s6, s6, 3
    s_mul_i32 s7, s6, 18432
    s_add_u32 s74, s7, s8
    s_lshl_b32 s7, s6, 11
    s_add_u32 s75, s7, s9
    s_add_u32 s6, s100, 0
    s_cmp_ge_u32 s6, 3
    s_cselect_b32 s7, 3, 0
    s_sub_u32 s6, s6, s7
    s_mul_i32 s7, s6, 384
    v_add_u32 v18, s7, v26
    s_mul_i32 s7, s6, 221184
    v_add_u32 v19, s7, v27
    s_waitcnt lgkmcnt(0)
    s_mov_b32 s48, s12
    s_mov_b32 s49, s13
    s_add_u32 m0, s78, 0
    s_nop 0
    buffer_load_dwordx4 v18, s[40:43], s72 offen offset:0  lds
    s_add_u32 m0, s78, 8064
    s_nop 0
    buffer_load_dwordx4 v18, s[40:43], s72 offen offset:128  lds
    s_add_u32 m0, s78, 16128
    s_nop 0
    buffer_load_dwordx4 v18, s[40:43], s72 offen offset:256  lds
    s_add_u32 m0, s79, 0
    s_nop 0
    buffer_load_dwordx4 v18, s[40:43], s73 offen offset:0  lds
    s_add_u32 m0, s79, 8064
    s_nop 0
    buffer_load_dwordx4 v18, s[40:43], s73 offen offset:128  lds
    s_add_u32 m0, s79, 16128
    s_nop 0
    buffer_load_dwordx4 v18, s[40:43], s73 offen offset:256  lds
    s_add_u32 m0, s75, 0
    s_nop 0
    buffer_load_dwordx4 v18, s[40:43], s74 offen offset:0  lds
    s_add_u32 m0, s75, 8064
    s_nop 0
    buffer_load_dwordx4 v18, s[40:43], s74 offen offset:128  lds
    s_add_u32 m0, s75, 16128
    s_nop 0
    buffer_load_dwordx4 v18, s[40:43], s74 offen offset:256  lds
    s_mov_b32 s46, 663552
    s_mov_b32 s47, 0x20000
    s_mov_b32 m0, s49
    s_mov_b32 s52, s48
    s_add_u32 s53, s48, 225792
L_w0:
    buffer_load_dwordx4 v19, s[44:47], s52 offen lds
    s_add_u32 m0, m0, 2016
    s_add_u32 s52, s52, 16128
    buffer_load_dwordx4 v19, s[44:47], s52 offen lds
    s_add_u32 m0, m0, 2016
    s_add_u32 s52, s52, 16128
    s_cmp_lt_u32 s52, s53
    s_cbranch_scc1 L_w0
    v_lshlrev_b32 v2, 2, v1
    v_mov_b32 v13, 1
    v_add_u32 v5, 0x40000, v2
    v_mov_b32 v2, 163776
    v_cmp_eq_u32 vcc, 0, v1
    s_nop 1
    v_cndmask_b32 v5, v5, v2, vcc
    s_add_u32 s52, s100, 1
    s_cmp_ge_u32 s52, 3
    s_cselect_b32 s53, 3, 0
    s_sub_u32 s52, s52, s53
    s_mul_i32 s53, s52, 384
    v_add_u32 v18, s53, v26
    s_add_u32 m0, s78, 24576
    s_nop 0
    buffer_load_dwordx4 v18, s[40:43], s72 offen offset:0  lds
    s_mov_b32 s70, 16777216
    s_mov_b32 s71, 0x20000
    s_mov_b32 s66, 256
    s_mov_b32 s67, 0x20000
    s_mov_b32 s46, 663552
    s_mov_b32 s47, 0x20000
    s_mov_b32 s58, 663552
    s_mov_b32 s59, 0x20000
    s_add_u32 m0, s78, 32640
    s_nop 0
    buffer_load_dwordx4 v18, s[40:43], s72 offen offset:128  lds
    s_mov_b32 s34, 2359296
    s_mov_b32 s35, 0x20000
    s_mov_b32 s38, 1152
    s_mov_b32 s39, 0x20000
    s_mov_b32 s62, 4718592
    s_mov_b32 s63, 0x20000
    s_mov_b32 s51, 0x20000
    s_mov_b32 s55, 0x20000
    s_add_u32 m0, s78, 40704
    s_nop 0
    buffer_load_dwordx4 v18, s[40:43], s72 offen offset:256  lds
    s_mov_b32 s80, 0
    v_mov_b32 v212, 0
    s_mul_i32 s82, s5, 72
    s_lshr_b32 s6, s4, 2
    s_mul_i32 s6, s6, 9
    s_add_u32 s82, s82, s6
    s_and_b32 s6, s4, 3
    s_lshl_b32 s6, s6, 1
    s_add_u32 m0, s79, 24576
    s_nop 0
    buffer_load_dwordx4 v18, s[40:43], s73 offen offset:0  lds
    s_add_u32 s81, s82, s6
    s_add_u32 s82, s82, 8
    s_cmp_lt_u32 s3, 4
    s_cselect_b32 s18, 0, 917504
    s_cselect_b32 s19, 0, 5120
    s_and_b32 s13, s3, 3
    s_lshr_b32 s12, s3, 2
    s_lshl_b32 s6, s13, 10
    s_add_u32 m0, s79, 32640
    s_nop 0
    buffer_load_dwordx4 v18, s[40:43], s73 offen offset:128  lds
    s_add_u32 s18, s18, s6
    s_add_u32 s19, s19, s6
    s_add_u32 s19, s19, 128
    s_lshl_b32 s6, s81, 12
    s_add_u32 s16, s6, s18
    s_add_u32 s17, s16, 4096
    s_lshl_b32 s6, s82, 12
    s_add_u32 s18, s6, s18
    s_add_u32 m0, s79, 40704
    s_nop 0
    buffer_load_dwordx4 v18, s[40:43], s73 offen offset:256  lds
    v_add_u32 v2, s81, v1
    v_writelane_b32 v2, s82, 2
    v_lshlrev_b32 v217, 12, v2
    v_lshlrev_b32 v216, 1, v2
    v_cmp_gt_u32 vcc, 3, v0
    v_mov_b32 v9, 0x80000000
    s_nop 0
    v_cndmask_b32 v217, v9, v217, vcc
    v_cndmask_b32 v216, v9, v216, vcc
    s_add_u32 m0, s75, 24576
    s_nop 0
    buffer_load_dwordx4 v18, s[40:43], s74 offen offset:0  lds
    s_mul_i32 s21, s5, 92160
    s_mul_i32 s7, s12, 46080
    s_add_u32 s21, s21, s7
    s_add_u32 s21, s21, 163840
    s_mul_i32 s20, s13, 9216
    s_add_u32 s20, s20, s21
    s_add_u32 s21, s21, 36864
    s_mul_i32 s23, s3, 1008
    s_add_u32 m0, s75, 32640
    s_nop 0
    buffer_load_dwordx4 v18, s[40:43], s74 offen offset:128  lds
    s_add_u32 s23, s23, 127264
    s_lshl_b32 s6, s4, 6
    s_lshl_b32 s7, s13, 4
    s_add_u32 s7, s7, s6
    v_and_b32 v2, 15, v1
    v_add_u32 v2, s7, v2
    v_mul_u32_u24 v3, 1152, v2
    s_mul_i32 s8, s5, 144
    s_add_u32 m0, s75, 40704
    s_nop 0
    buffer_load_dwordx4 v18, s[40:43], s74 offen offset:256  lds
    s_lshl_b32 s7, s12, 6
    s_add_u32 s7, s7, s8
    v_lshl_add_u32 v2, v10, 4, s7
    v_add_u32 v238, v3, v2
    v_lshl_add_u32 v6, v3, 1, v2
    v_add_u32 v2, s6, v1
    v_mul_u32_u24 v3, 1152, v2
    s_add_u32 s9, s8, 128
    s_waitcnt vmcnt(9)
    ds_add_u32 v5, v13 offset:8
    s_add_u32 s52, s100, 2
    s_cmp_ge_u32 s52, 3
    s_cselect_b32 s53, 3, 0
    s_sub_u32 s52, s52, s53
    s_mul_i32 s53, s52, 384
    v_add_u32 v18, s53, v26
    s_mul_i32 s53, s52, 221184
    v_add_u32 v19, s53, v27
    s_add_u32 m0, s78, 49152
    s_nop 0
    buffer_load_dwordx4 v18, s[40:43], s72 offen offset:0  lds
    v_add_u32 v239, s9, v3
    v_lshl_add_u32 v15, v3, 1, s9
    v_mov_b32 v255, v6
    s_cmp_eq_u32 s3, 3
    s_cselect_b64 vcc, -1, 0
    v_cndmask_b32 v239, v9, v239, vcc
    v_lshlrev_b32 v240, 2, v1
    v_mul_u32_u24 v2, 7282, v1
    s_add_u32 m0, s78, 57216
    s_nop 0
    buffer_load_dwordx4 v18, s[40:43], s72 offen offset:128  lds
    v_lshrrev_b32 v2, 16, v2
    v_mul_u32_u24 v2, 1008, v2
    v_lshlrev_b32 v7, 4, v1
    s_mul_i32 s7, s3, 7
    s_add_u32 s7, s7, s6
    s_mul_i32 s7, s7, 1152
    s_add_u32 s7, s7, s8
    v_add3_u32 v241, v2, v7, s7
    s_add_u32 m0, s78, 65280
    s_nop 0
    buffer_load_dwordx4 v18, s[40:43], s72 offen offset:256  lds
    v_subrev_u32 v242, 3456, v241
    v_mov_b32 v13, 1
    v_mov_b32 v2, 163776
    v_cmp_eq_u32 vcc, 0, v1
    s_mul_i32 s10, s5, 576
    v_lshrrev_b32 v2, 3, v1
    v_mul_u32_u24 v2, 1152, v2
    v_and_b32 v7, 7, v1
    s_add_u32 m0, s79, 49152
    s_nop 0
    buffer_load_dwordx4 v18, s[40:43], s73 offen offset:0  lds
    s_lshl_b32 s7, s13, 3
    v_add_u32 v7, s7, v7
    v_lshl_add_u32 v243, v7, 2, v2
    v_lshl_add_u32 v246, v7, 4, s10
    v_add_u32 v244, 128416, v243
    v_add_u32 v245, 137360, v243
    v_add_u32 v243, 127264, v243
    v_lshlrev_b32 v14, 4, v1
    s_add_u32 m0, s79, 57216
    s_nop 0
    buffer_load_dwordx4 v18, s[40:43], s73 offen offset:128  lds
    s_mul_i32 s6, s3, 3072
    s_add_u32 s6, s6, 36864
    s_xor_b32 s7, s3, 4
    s_mul_i32 s7, s7, 3072
    s_add_u32 s7, s7, 36864
    v_add_u32 v236, s6, v14
    v_add_u32 v237, s7, v14
    s_mul_i32 s6, s12, 9344
    s_add_u32 m0, s79, 65280
    s_nop 0
    buffer_load_dwordx4 v18, s[40:43], s73 offen offset:256  lds
    v_lshlrev_b32 v2, 5, v12
    v_lshlrev_b32 v3, 6, v10
    v_sub_u32 v2, v2, v3
    v_lshlrev_b32 v7, 3, v11
    v_sub_u32 v2, v2, v7
    s_add_u32 s7, s6, 248
    v_add_u32 v232, s7, v2
    v_add_u32 v234, 18936, v2
    s_add_u32 m0, s75, 49152
    s_nop 0
    buffer_load_dwordx4 v18, s[40:43], s74 offen offset:0  lds
    v_lshl_add_u32 v2, v12, 3, v3
    v_add_u32 v2, v2, v7
    s_lshl_b32 s8, s13, 7
    s_add_u32 s7, s6, s8
    s_add_u32 s7, s7, 4840
    v_add_u32 v233, s7, v2
    s_sub_u32 s30, 7, s13
    s_cmp_eq_u32 s12, 1
    s_cselect_b32 s30, s13, s30
    s_add_u32 m0, s75, 57216
    s_nop 0
    buffer_load_dwordx4 v18, s[40:43], s74 offen offset:128  lds
    s_and_b32 s9, s4, 3
    s_lshl_b32 s7, s30, 9
    s_lshl_b32 s8, s9, 7
    s_add_u32 s7, s7, s8
    s_add_u32 s7, s7, 19944
    v_add_u32 v235, s7, v2
    s_add_u32 s6, s81, s12
    s_lshl_b32 s8, s6, 3
    s_add_u32 m0, s75, 65280
    s_nop 0
    buffer_load_dwordx4 v18, s[40:43], s74 offen offset:256  lds
    s_lshl_b32 s6, s6, 12
    s_lshl_b32 s7, s13, 7
    s_add_u32 s6, s6, s7
    s_add_u32 s26, s6, 3276800
    s_mul_i32 s7, s13, 4608
    s_add_u32 s8, s8, s7
    s_add_u32 s27, s8, 8000000
    s_lshl_b32 s7, s30, 2
    s_waitcnt vmcnt(9)
    ds_add_u32 v5, v13 offset:12
    s_add_u32 m0, s49, 28240
    s_add_u32 s52, s48, 0
    buffer_load_dwordx4 v19, s[44:47], s52 offen lds
    s_add_u32 s7, s7, s9
    s_lshl_b32 s6, s82, 12
    s_lshl_b32 s8, s7, 7
    s_add_u32 s6, s6, s8
    s_add_u32 s28, s6, 3276800
    s_mul_i32 s7, s7, 4608
    s_lshl_b32 s8, s82, 3
    s_add_u32 s8, s8, s7
    s_cmp_eq_u32 s3, 4
    s_cbranch_scc0 L_w5go
    s_add_u32 s29, s8, 8000000
    s_and_b32 s10, s3, 1
    s_bfe_u32 s11, s3, 0x10001
    s_lshl_b32 s11, s11, 1
    s_add_u32 s11, s11, s12
    s_lshl_b32 s6, s4, 2
    s_lshl_b32 s7, s10, 1
    s_add_u32 s6, s6, s7
    s_lshl_b32 s6, s6, 1
    s_lshr_b32 s7, s5, 2
    s_add_u32 s6, s6, s7
    s_mul_i32 s6, s6, 9216
    s_and_b32 s7, s5, 3
    s_lshl_b32 s7, s7, 8
    s_add_u32 s6, s6, s7
    s_add_u32 s6, s6, 5636096
    s_lshl_b32 s7, s11, 11
    s_add_u32 s24, s6, s7
    s_lshl_b32 s7, s11, 2
    s_add_u32 s6, s6, s7
    s_add_u32 s25, s6, 8192
    v_and_b32 v2, 15, v1
    v_lshlrev_b32 v2, 4, v2
    v_bfe_u32 v3, v1, 4, 1
    v_mul_u32_u24 v3, 18432, v3
    v_add_u32 v254, v2, v3
    v_lshrrev_b32 v3, 5, v1
    v_lshl_add_u32 v253, v3, 10, v254
    v_mov_b32 v248, -1
    v_mov_b32 v249, -1
    v_mov_b32 v250, -1
    v_mov_b32 v251, -1
    s_mul_i32 s6, s4, 73728
    s_mul_i32 s7, s5, 9216
    s_add_u32 s6, s6, s7
    s_add_u32 s6, s6, 5636096
    s_lshl_b32 s7, s3, 10
    s_add_u32 s31, s6, s7
    s_add_u32 s6, s6, 8192
    s_mul_i32 s8, s5, 294912
    s_lshl_b32 s7, s4, 7
    s_add_u32 s8, s8, s7
    s_add_u32 s8, s8, 3276800
    v_lshrrev_b32 v2, 3, v1
    v_lshlrev_b32 v2, 12, v2
    v_and_b32 v3, 7, v1
    v_lshl_add_u32 v2, v3, 4, v2
    s_lshl_b32 s7, s3, 15
    s_add_u32 s7, s7, s8
    v_add_u32 v206, s7, v2
    s_add_u32 s8, s8, 262144
    v_add_u32 v2, s8, v2
    s_mul_i32 s8, s4, 4608
    s_mul_i32 s7, s5, 576
    s_add_u32 s8, s8, s7
    s_add_u32 s8, s8, 7995392
    s_cmp_eq_u32 s3, 0
    s_cselect_b32 s6, s6, s8
    v_add_u32 v207, s6, v14
    s_cmp_eq_u32 s3, 1
    s_cselect_b64 vcc, -1, 0
    v_cndmask_b32 v207, v207, v2, vcc
    v_cmp_gt_u32 vcc, 164, v0
    s_nop 1
    v_cndmask_b32 v207, v9, v207, vcc
    s_lshr_b32 s12, s3, 2
    s_mul_i32 s6, s12, 18432
    v_add_u32 v157, s6, v14
    v_and_b32 v2, 31, v1
    v_lshlrev_b32 v3, 4, v2
    s_add_u32 s7, s6, 8192
    v_add_u32 v158, s7, v3
    v_lshrrev_b32 v8, 5, v1
    v_mul_u32_u24 v7, 288, v8
    s_add_u32 s7, s6, 9216
    v_add3_u32 v159, v3, v7, s7
    s_mov_b32 s76, 0x3ffff
    s_mov_b32 s77, 0x3ffff
    v_mov_b32 v156, 0xdddddddd
    v_cmp_eq_u32 vcc, 18, v2
    v_mov_b32 v7, 0x3f803f80
    s_nop 0
    v_cndmask_b32 v7, 0, v7, vcc
    v_mov_b32 v140, v7
    v_mov_b32 v141, v7
    v_mov_b32 v142, v7
    v_mov_b32 v143, v7
    v_mov_b32 v144, v7
    v_mov_b32 v145, v7
    v_mov_b32 v146, v7
    v_mov_b32 v147, v7
    v_mov_b32 v148, v7
    v_mov_b32 v149, v7
    v_mov_b32 v150, v7
    v_mov_b32 v151, v7
    v_mov_b32 v152, v7
    v_mov_b32 v153, v7
    v_mov_b32 v154, v7
    v_mov_b32 v155, v7
    v_mov_b32 v80, 0
    v_mov_b32 v81, 0
    v_mov_b32 v82, 0
    v_mov_b32 v83, 0
    v_mov_b32 v84, 0
    v_mov_b32 v85, 0
    v_mov_b32 v86, 0
    v_mov_b32 v87, 0
    v_mov_b32 v88, 0
    v_mov_b32 v89, 0
    v_mov_b32 v90, 0
    v_mov_b32 v91, 0
    v_mov_b32 v92, 0
    v_mov_b32 v93, 0
    v_mov_b32 v94, 0
    v_mov_b32 v95, 0
    v_mov_b32 v96, 0
    v_mov_b32 v97, 0
    v_mov_b32 v98, 0
    v_mov_b32 v99, 0
    v_mov_b32 v100, 0
    v_mov_b32 v101, 0
    v_mov_b32 v102, 0
    v_mov_b32 v103, 0
    v_mov_b32 v104, 0
    v_mov_b32 v105, 0
    v_mov_b32 v106, 0
    v_mov_b32 v107, 0
    v_mov_b32 v108, 0
    v_mov_b32 v109, 0
    v_mov_b32 v110, 0
    v_mov_b32 v111, 0
    s_and_b32 s10, s3, 1
    s_bfe_u32 s11, s3, 0x10001
    s_lshl_b32 s6, s10, 5
    v_add_u32 v2, s6, v2
    v_mul_u32_u24 v2, 208, v2
    s_lshl_b32 s6, s11, 1
    s_add_u32 s7, s6, s12
    s_mul_i32 s7, s7, 48
    s_add_u32 s7, s7, 147456
    s_xor_b32 s8, s12, 1
    s_add_u32 s8, s8, s6
    s_mul_i32 s8, s8, 48
    s_add_u32 s8, s8, 147456
    v_lshl_add_u32 v3, v8, 4, v2
    v_add_u32 v112, s7, v3
    v_add_u32 v116, s8, v3
    v_xor_b32 v3, s12, v8
    v_add_u32 v3, s6, v3
    v_mul_u32_u24 v3, 48, v3
    v_add_u32 v3, v3, v2
    v_add_u32 v120, 147488, v3
    v_add_u32 v123, 147488, v3
    v_mov_b32 v121, 0
    v_mov_b32 v122, 0
    s_branch L_w4done
L_w5go:
    s_mov_b32 s48, 0
    s_mov_b32 s49, 73728
    s_add_u32 m0, s49, 30256
    s_add_u32 s52, s48, 16128
    buffer_load_dwordx4 v19, s[44:47], s52 offen lds
    s_add_u32 s29, s8, 8000000
    s_and_b32 s10, s3, 1
    s_bfe_u32 s11, s3, 0x10001
    s_lshl_b32 s11, s11, 1
    s_add_u32 s11, s11, s12
    s_lshl_b32 s6, s4, 2
    s_lshl_b32 s7, s10, 1
    s_add_u32 s6, s6, s7
    s_add_u32 m0, s49, 31264
    s_add_u32 s52, s48, 24192
    buffer_load_dwordx4 v19, s[44:47], s52 offen lds
    s_lshl_b32 s6, s6, 1
    s_lshr_b32 s7, s5, 2
    s_add_u32 s6, s6, s7
    s_mul_i32 s6, s6, 9216
    s_and_b32 s7, s5, 3
    s_lshl_b32 s7, s7, 8
    s_add_u32 s6, s6, s7
    s_add_u32 s6, s6, 5636096
    s_add_u32 m0, s49, 32272
    s_add_u32 s52, s48, 32256
    buffer_load_dwordx4 v19, s[44:47], s52 offen lds
    s_lshl_b32 s7, s11, 11
    s_add_u32 s24, s6, s7
    s_lshl_b32 s7, s11, 2
    s_add_u32 s6, s6, s7
    s_add_u32 s25, s6, 8192
    v_and_b32 v2, 15, v1
    v_lshlrev_b32 v2, 4, v2
    v_bfe_u32 v3, v1, 4, 1
    s_add_u32 m0, s49, 33280
    s_add_u32 s52, s48, 40320
    buffer_load_dwordx4 v19, s[44:47], s52 offen lds
    v_mul_u32_u24 v3, 18432, v3
    v_add_u32 v254, v2, v3
    v_lshrrev_b32 v3, 5, v1
    v_lshl_add_u32 v253, v3, 10, v254
    v_mov_b32 v248, -1
    v_mov_b32 v249, -1
    v_mov_b32 v250, -1
    v_mov_b32 v251, -1
    s_add_u32 m0, s49, 34288
    s_add_u32 s52, s48, 48384
    buffer_load_dwordx4 v19, s[44:47], s52 offen lds
    s_mul_i32 s6, s4, 73728
    s_mul_i32 s7, s5, 9216
    s_add_u32 s6, s6, s7
    s_add_u32 s6, s6, 5636096
    s_lshl_b32 s7, s3, 10
    s_add_u32 s31, s6, s7
    s_add_u32 s6, s6, 8192
    s_mul_i32 s8, s5, 294912
    s_add_u32 m0, s49, 35296
    s_add_u32 s52, s48, 56448
    buffer_load_dwordx4 v19, s[44:47], s52 offen lds
    s_lshl_b32 s7, s4, 7
    s_add_u32 s8, s8, s7
    s_add_u32 s8, s8, 3276800
    v_lshrrev_b32 v2, 3, v1
    v_lshlrev_b32 v2, 12, v2
    v_and_b32 v3, 7, v1
    v_lshl_add_u32 v2, v3, 4, v2
    s_lshl_b32 s7, s3, 15
    s_add_u32 m0, s49, 36304
    s_add_u32 s52, s48, 64512
    buffer_load_dwordx4 v19, s[44:47], s52 offen lds
    s_add_u32 s7, s7, s8
    v_add_u32 v206, s7, v2
    s_add_u32 s8, s8, 262144
    v_add_u32 v2, s8, v2
    s_mul_i32 s8, s4, 4608
    s_mul_i32 s7, s5, 576
    s_add_u32 s8, s8, s7
    s_add_u32 s8, s8, 7995392
    s_add_u32 m0, s49, 37312
    s_add_u32 s52, s48, 72576
    buffer_load_dwordx4 v19, s[44:47], s52 offen lds
    s_cmp_eq_u32 s3, 0
    s_cselect_b32 s6, s6, s8
    v_add_u32 v207, s6, v14
    s_cmp_eq_u32 s3, 1
    s_cselect_b64 vcc, -1, 0
    v_cndmask_b32 v207, v207, v2, vcc
    v_cmp_gt_u32 vcc, 164, v0
    s_nop 1
    v_cndmask_b32 v207, v9, v207, vcc
    s_add_u32 m0, s49, 38320
    s_add_u32 s52, s48, 80640
    buffer_load_dwordx4 v19, s[44:47], s52 offen lds
    s_lshr_b32 s12, s3, 2
    s_mul_i32 s6, s12, 18432
    v_add_u32 v157, s6, v14
    v_and_b32 v2, 31, v1
    v_lshlrev_b32 v3, 4, v2
    s_add_u32 s7, s6, 8192
    v_add_u32 v158, s7, v3
    v_lshrrev_b32 v8, 5, v1
    s_add_u32 m0, s49, 39328
    s_add_u32 s52, s48, 88704
    buffer_load_dwordx4 v19, s[44:47], s52 offen lds
    v_mul_u32_u24 v7, 288, v8
    s_add_u32 s7, s6, 9216
    v_add3_u32 v159, v3, v7, s7
    s_mov_b32 s76, 0x3ffff
    s_mov_b32 s77, 0x3ffff
    v_mov_b32 v156, 0xdddddddd
    v_cmp_eq_u32 vcc, 18, v2
    v_mov_b32 v7, 0x3f803f80
    s_add_u32 m0, s49, 40336
    s_add_u32 s52, s48, 96768
    buffer_load_dwordx4 v19, s[44:47], s52 offen lds
    v_cndmask_b32 v7, 0, v7, vcc
    v_mov_b32 v140, v7
    v_mov_b32 v141, v7
    v_mov_b32 v142, v7
    v_mov_b32 v143, v7
    v_mov_b32 v144, v7
    v_mov_b32 v145, v7
    v_mov_b32 v146, v7
    s_add_u32 m0, s49, 41344
    s_add_u32 s52, s48, 104832
    buffer_load_dwordx4 v19, s[44:47], s52 offen lds
    v_mov_b32 v147, v7
    v_mov_b32 v148, v7
    v_mov_b32 v149, v7
    v_mov_b32 v150, v7
    v_mov_b32 v151, v7
    v_mov_b32 v152, v7
    v_mov_b32 v153, v7
    v_mov_b32 v154, v7
    s_add_u32 m0, s49, 42352
    s_add_u32 s52, s48, 112896
    buffer_load_dwordx4 v19, s[44:47], s52 offen lds
    v_mov_b32 v155, v7
    v_mov_b32 v80, 0
    v_mov_b32 v81, 0
    v_mov_b32 v82, 0
    v_mov_b32 v83, 0
    v_mov_b32 v84, 0
    v_mov_b32 v85, 0
    v_mov_b32 v86, 0
    s_add_u32 m0, s49, 43360
    s_add_u32 s52, s48, 120960
    buffer_load_dwordx4 v19, s[44:47], s52 offen lds
    v_mov_b32 v87, 0
    v_mov_b32 v88, 0
    v_mov_b32 v89, 0
    v_mov_b32 v90, 0
    v_mov_b32 v91, 0
    v_mov_b32 v92, 0
    v_mov_b32 v93, 0
    v_mov_b32 v94, 0
    s_add_u32 m0, s49, 44368
    s_add_u32 s52, s48, 129024
    buffer_load_dwordx4 v19, s[44:47], s52 offen lds
    v_mov_b32 v95, 0
    v_mov_b32 v96, 0
    v_mov_b32 v97, 0
    v_mov_b32 v98, 0
    v_mov_b32 v99, 0
    v_mov_b32 v100, 0
    v_mov_b32 v101, 0
    v_mov_b32 v102, 0
    s_add_u32 m0, s49, 45376
    s_add_u32 s52, s48, 137088
    buffer_load_dwordx4 v19, s[44:47], s52 offen lds
    v_mov_b32 v103, 0
    v_mov_b32 v104, 0
    v_mov_b32 v105, 0
    v_mov_b32 v106, 0
    v_mov_b32 v107, 0
    v_mov_b32 v108, 0
    v_mov_b32 v109, 0
    v_mov_b32 v110, 0
    s_add_u32 m0, s49, 46384
    s_add_u32 s52, s48, 145152
    buffer_load_dwordx4 v19, s[44:47], s52 offen lds
    v_mov_b32 v111, 0
    s_and_b32 s10, s3, 1
    s_bfe_u32 s11, s3, 0x10001
    s_lshl_b32 s6, s10, 5
    v_add_u32 v2, s6, v2
    v_mul_u32_u24 v2, 208, v2
    s_lshl_b32 s6, s11, 1
    s_add_u32 s7, s6, s12
    s_add_u32 m0, s49, 47392
    s_add_u32 s52, s48, 153216
    buffer_load_dwordx4 v19, s[44:47], s52 offen lds
    s_mul_i32 s7, s7, 48
    s_add_u32 s7, s7, 147456
    s_xor_b32 s8, s12, 1
    s_add_u32 s8, s8, s6
    s_mul_i32 s8, s8, 48
    s_add_u32 s8, s8, 147456
    v_lshl_add_u32 v3, v8, 4, v2
    v_add_u32 v112, s7, v3
    s_add_u32 m0, s49, 48400
    s_add_u32 s52, s48, 161280
    buffer_load_dwordx4 v19, s[44:47], s52 offen lds
    v_add_u32 v116, s8, v3
    v_xor_b32 v3, s12, v8
    v_add_u32 v3, s6, v3
    v_mul_u32_u24 v3, 48, v3
    v_add_u32 v3, v3, v2
    v_add_u32 v120, 147488, v3
    v_add_u32 v123, 147488, v3
    v_mov_b32 v121, 0
    s_add_u32 m0, s49, 49408
    s_add_u32 s52, s48, 169344
    buffer_load_dwordx4 v19, s[44:47], s52 offen lds
    v_mov_b32 v122, 0
    s_add_u32 m0, s49, 50416
    s_add_u32 s52, s48, 177408
    buffer_load_dwordx4 v19, s[44:47], s52 offen lds
    s_add_u32 m0, s49, 51424
    s_add_u32 s52, s48, 185472
    buffer_load_dwordx4 v19, s[44:47], s52 offen lds
    s_add_u32 m0, s49, 52432
    s_add_u32 s52, s48, 193536
    buffer_load_dwordx4 v19, s[44:47], s52 offen lds
    s_add_u32 m0, s49, 53440
    s_add_u32 s52, s48, 201600
    buffer_load_dwordx4 v19, s[44:47], s52 offen lds
    s_add_u32 m0, s49, 54448
    s_add_u32 s52, s48, 209664
    buffer_load_dwordx4 v19, s[44:47], s52 offen lds
    s_add_u32 m0, s49, 55456
    s_add_u32 s52, s48, 217728
    buffer_load_dwordx4 v19, s[44:47], s52 offen lds
    v_mov_b32 v16, 0x100
    ds_add_u32 v5, v16 offset:20
L_w4done:
    s_waitcnt vmcnt(0)
    ds_add_u32 v5, v13 offset:16
    s_cmp_eq_u32 s3, 4
    s_cbranch_scc0 L_nopoll1
    v_mov_b32 v7, 163796
    s_mov_b32 s83, 200000
L_lw_5:
    ds_read_b32 v2, v7
    s_waitcnt lgkmcnt(0)
    v_readfirstlane_b32 s6, v2
    s_nop 0
    s_cmp_ge_u32 s6, 262
    s_cbranch_scc1 L_lw_5d
    s_sleep 1
    s_sub_u32 s83, s83, 1
    s_cmp_lg_u32 s83, 0
    s_cbranch_scc1 L_lw_5
L_lw_5d:
    v_lshlrev_b32 v2, 2, v1
    s_mov_b32 s83, 20000
L_poll_b1:
    buffer_load_dword v3, v2, s[64:67], 0 offen sc1
    s_waitcnt vmcnt(0)
    v_bfe_u32 v3, v3, 0, 8
    v_cmp_ne_u32 vcc, 4, v3
    s_nop 0
    s_cmp_eq_u64 vcc, 0
    s_cbranch_scc1 L_polled_b1
    s_sleep 4
    s_sub_u32 s83, s83, 1
    s_cmp_lg_u32 s83, 0
    s_cbranch_scc1 L_poll_b1
L_polled_b1:
    s_mov_b32 s8, 0
    s_mov_b32 m0, 0
    s_nop 0
    buffer_load_dwordx4 v14, s[68:71], s8 offen offset:0 sc1 lds
    buffer_load_dwordx4 v14, s[68:71], s8 offen offset:1024 sc1 lds
    buffer_load_dwordx4 v14, s[68:71], s8 offen offset:2048 sc1 lds
    buffer_load_dwordx4 v14, s[68:71], s8 offen offset:3072 sc1 lds
    s_add_u32 m0, m0, 4096
    s_add_u32 s8, s8, 4096
    buffer_load_dwordx4 v14, s[68:71], s8 offen offset:0 sc1 lds
    buffer_load_dwordx4 v14, s[68:71], s8 offen offset:1024 sc1 lds
    buffer_load_dwordx4 v14, s[68:71], s8 offen offset:2048 sc1 lds
    buffer_load_dwordx4 v14, s[68:71], s8 offen offset:3072 sc1 lds
    s_add_u32 m0, m0, 4096
    s_add_u32 s8, s8, 4096
    buffer_load_dwordx4 v14, s[68:71], s8 offen offset:0 sc1 lds
    buffer_load_dwordx4 v14, s[68:71], s8 offen offset:1024 sc1 lds
    buffer_load_dwordx4 v14, s[68:71], s8 offen offset:2048 sc1 lds
    buffer_load_dwordx4 v14, s[68:71], s8 offen offset:3072 sc1 lds
    s_add_u32 m0, m0, 4096
    s_add_u32 s8, s8, 4096
    buffer_load_dwordx4 v14, s[68:71], s8 offen offset:0 sc1 lds
    buffer_load_dwordx4 v14, s[68:71], s8 offen offset:1024 sc1 lds
    buffer_load_dwordx4 v14, s[68:71], s8 offen offset:2048 sc1 lds
    buffer_load_dwordx4 v14, s[68:71], s8 offen offset:3072 sc1 lds
    s_add_u32 m0, m0, 4096
    s_add_u32 s8, s8, 4096
    buffer_load_dwordx4 v14, s[68:71], s8 offen offset:0 sc1 lds
    buffer_load_dwordx4 v14, s[68:71], s8 offen offset:1024 sc1 lds
    buffer_load_dwordx4 v14, s[68:71], s8 offen offset:2048 sc1 lds
    buffer_load_dwordx4 v14, s[68:71], s8 offen offset:3072 sc1 lds
    s_add_u32 m0, m0, 4096
    s_add_u32 s8, s8, 4096
    buffer_load_dwordx4 v14, s[68:71], s8 offen offset:0 sc1 lds
    buffer_load_dwordx4 v14, s[68:71], s8 offen offset:1024 sc1 lds
    buffer_load_dwordx4 v14, s[68:71], s8 offen offset:2048 sc1 lds
    buffer_load_dwordx4 v14, s[68:71], s8 offen offset:3072 sc1 lds
    s_add_u32 m0, m0, 4096
    s_add_u32 s8, s8, 4096
    buffer_load_dwordx4 v14, s[68:71], s8 offen offset:0 sc1 lds
    buffer_load_dwordx4 v14, s[68:71], s8 offen offset:1024 sc1 lds
    buffer_load_dwordx4 v14, s[68:71], s8 offen offset:2048 sc1 lds
    buffer_load_dwordx4 v14, s[68:71], s8 offen offset:3072 sc1 lds
    s_add_u32 m0, m0, 4096
    s_add_u32 s8, s8, 4096
    buffer_load_dwordx4 v14, s[68:71], s8 offen offset:0 sc1 lds
    buffer_load_dwordx4 v14, s[68:71], s8 offen offset:1024 sc1 lds
    buffer_load_dwordx4 v14, s[68:71], s8 offen offset:2048 sc1 lds
    buffer_load_dwordx4 v14, s[68:71], s8 offen offset:3072 sc1 lds
    s_add_u32 m0, m0, 4096
    s_add_u32 s8, s8, 4096
    buffer_load_dwordx4 v14, s[68:71], s8 offen offset:0 sc1 lds
    buffer_load_dwordx4 v14, s[68:71], s8 offen offset:1024 sc1 lds
    buffer_load_dwordx4 v14, s[68:71], s8 offen offset:2048 sc1 lds
    buffer_load_dwordx4 v14, s[68:71], s8 offen offset:3072 sc1 lds
    s_add_u32 m0, m0, 4096
    s_add_u32 s8, s8, 4096
    buffer_load_dwordx4 v14, s[68:71], s8 offen offset:0 sc1 lds
    buffer_load_dwordx4 v14, s[68:71], s8 offen offset:1024 sc1 lds
    buffer_load_dwordx4 v14, s[68:71], s8 offen offset:2048 sc1 lds
    buffer_load_dwordx4 v14, s[68:71], s8 offen offset:3072 sc1 lds
L_nopoll1:
    s_branch L_dma0
L_ret_q:
    v_mul_u32_u24 v2, 7282, v1
    v_lshrrev_b32 v2, 16, v2
    v_mul_u32_u24 v2, 1008, v2
    v_lshlrev_b32 v3, 4, v1
    s_mul_i32 s6, s5, 144
    v_add3_u32 v27, v3, v2, s6
    s_mul_i32 s12, s3, 8064
    s_mul_i32 s13, s3, 1008
    s_add_u32 s13, s13, 130208
    v_add_u32 v28, s13, v3
    s_mov_b32 s46, 663552
    s_mov_b32 s47, 0x20000
    s_waitcnt lgkmcnt(0)
    s_add_u32 s6, s100, 1
    s_cmp_ge_u32 s6, 3
    s_cselect_b32 s7, 3, 0
    s_sub_u32 s6, s6, s7
    s_mul_i32 s7, s6, 221184
    v_add_u32 v19, s7, v27
    s_add_u32 s6, s12, 0
    buffer_load_dwordx4 v[160:163], v19, s[44:47], s6 offen
    s_add_u32 s6, s12, 32256
    buffer_load_dwordx4 v[164:167], v19, s[44:47], s6 offen
    s_add_u32 s6, s12, 64512
    buffer_load_dwordx4 v[168:171], v19, s[44:47], s6 offen
    s_add_u32 s6, s12, 96768
    buffer_load_dwordx4 v[172:175], v19, s[44:47], s6 offen
    s_add_u32 s6, s12, 129024
    buffer_load_dwordx4 v[192:195], v19, s[44:47], s6 offen
    s_add_u32 s6, s12, 161280
    buffer_load_dwordx4 v[196:199], v19, s[44:47], s6 offen
    s_add_u32 s6, s12, 193536
    buffer_load_dwordx4 v[200:203], v19, s[44:47], s6 offen
    s_and_b32 s10, s3, 1
    s_lshr_b32 s11, s3, 1
    s_lshl_b32 s6, s10, 5
    v_and_b32 v16, 31, v1
    v_add_u32 v16, s6, v16
    v_lshlrev_b32 v3, 7, v16
    v_bfe_u32 v7, v16, 1, 3
    v_lshrrev_b32 v8, 5, v1
    v_xor_b32 v7, v7, v8
    v_xor_b32 v9, 0, v7
    v_lshl_add_u32 v20, v9, 4, v3
    v_xor_b32 v9, 2, v7
    v_lshl_add_u32 v21, v9, 4, v3
    v_xor_b32 v9, 4, v7
    v_lshl_add_u32 v22, v9, 4, v3
    v_xor_b32 v9, 6, v7
    v_lshl_add_u32 v23, v9, 4, v3
    v_lshl_add_u32 v9, v8, 3, v11
    v_mul_u32_u24 v9, 144, v9
    v_lshl_add_u32 v9, v12, 3, v9
    v_and_b32 v7, 1, v10
    v_lshl_add_u32 v9, v7, 5, v9
    s_lshl_b32 s6, s11, 6
    s_add_u32 s6, s6, 73728
    v_add_u32 v24, s6, v9
    v_mul_u32_u24 v2, 208, v16
    v_add_u32 v2, 147456, v2
    v_lshl_add_u32 v17, v8, 3, v2
    v_mul_u32_u24 v18, 20, v8
    v_add_u32 v18, v18, v2
    v_mov_b32 v7, 163780
    s_mov_b32 s83, 200000
L_lw_6:
    ds_read_b32 v2, v7
    s_waitcnt lgkmcnt(0)
    v_readfirstlane_b32 s6, v2
    s_nop 0
    s_cmp_ge_u32 s6, 1
    s_cbranch_scc1 L_lw_6d
    s_sleep 1
    s_sub_u32 s83, s83, 1
    s_cmp_lg_u32 s83, 0
    s_cbranch_scc1 L_lw_6
L_lw_6d:
    s_waitcnt vmcnt(0)
    ds_write_b128 v28, v[160:163] offset:0
    ds_write_b128 v28, v[164:167] offset:4032
    ds_write_b128 v28, v[168:171] offset:8064
    ds_write_b128 v28, v[172:175] offset:12096
    ds_write_b128 v28, v[192:195] offset:16128
    ds_write_b128 v28, v[196:199] offset:20160
    ds_write_b128 v28, v[200:203] offset:24192
    ds_add_u32 v5, v13 offset:12
    v_mov_b32 v7, 163784
    s_mov_b32 s83, 200000
L_lw_7:
    ds_read_b32 v2, v7
    s_waitcnt lgkmcnt(0)
    v_readfirstlane_b32 s6, v2
    s_nop 0
    s_cmp_ge_u32 s6, 3
    s_cbranch_scc1 L_lw_7d
    s_sleep 1
    s_sub_u32 s83, s83, 1
    s_cmp_lg_u32 s83, 0
    s_cbranch_scc1 L_lw_7
L_lw_7d:
    ds_read_b128 v[32:35], v20 offset:0
    ds_read_b64_tr_b16 v[56:57], v24 offset:0
    ds_read_b64_tr_b16 v[58:59], v24 offset:576
    ds_read_b128 v[36:39], v21 offset:0
    ds_read_b64_tr_b16 v[60:61], v24 offset:2304
    ds_read_b64_tr_b16 v[62:63], v24 offset:2880
    ds_read_b128 v[40:43], v22 offset:0
    ds_read_b64_tr_b16 v[64:65], v24 offset:4608
    ds_read_b64_tr_b16 v[66:67], v24 offset:5184
    ds_read_b128 v[44:47], v23 offset:0
    ds_read_b64_tr_b16 v[68:69], v24 offset:6912
    ds_read_b64_tr_b16 v[70:71], v24 offset:7488
    s_waitcnt lgkmcnt(9)
    v_mfma_f32_32x32x16_bf16 v[176:191], v[56:59], v[32:35], 0
    ds_read_b128 v[48:51], v20 offset:8192
    ds_read_b64_tr_b16 v[72:73], v24 offset:9216
    ds_read_b64_tr_b16 v[74:75], v24 offset:9792
    s_waitcnt lgkmcnt(9)
    v_mfma_f32_32x32x16_bf16 v[176:191], v[60:63], v[36:39], v[176:191]
    ds_read_b128 v[52:55], v21 offset:8192
    ds_read_b64_tr_b16 v[76:77], v24 offset:11520
    ds_read_b64_tr_b16 v[78:79], v24 offset:12096
    s_waitcnt lgkmcnt(9)
    v_mfma_f32_32x32x16_bf16 v[176:191], v[64:67], v[40:43], v[176:191]
    ds_read_b128 v[32:35], v22 offset:8192
    ds_read_b64_tr_b16 v[56:57], v24 offset:13824
    ds_read_b64_tr_b16 v[58:59], v24 offset:14400
    s_waitcnt lgkmcnt(9)
    v_mfma_f32_32x32x16_bf16 v[176:191], v[68:71], v[44:47], v[176:191]
    ds_read_b128 v[36:39], v23 offset:8192
    ds_read_b64_tr_b16 v[60:61], v24 offset:16128
    ds_read_b64_tr_b16 v[62:63], v24 offset:16704
    s_waitcnt lgkmcnt(9)
    v_mfma_f32_32x32x16_bf16 v[176:191], v[72:75], v[48:51], v[176:191]
    ds_read_b128 v[40:43], v20 offset:16384
    ds_read_b64_tr_b16 v[64:65], v24 offset:18432
    ds_read_b64_tr_b16 v[66:67], v24 offset:19008
    s_waitcnt lgkmcnt(9)
    v_mfma_f32_32x32x16_bf16 v[176:191], v[76:79], v[52:55], v[176:191]
    ds_read_b128 v[44:47], v21 offset:16384
    ds_read_b64_tr_b16 v[68:69], v24 offset:20736
    ds_read_b64_tr_b16 v[70:71], v24 offset:21312
    s_waitcnt lgkmcnt(9)
    v_mfma_f32_32x32x16_bf16 v[176:191], v[56:59], v[32:35], v[176:191]
    ds_read_b128 v[48:51], v22 offset:16384
    ds_read_b64_tr_b16 v[72:73], v24 offset:23040
    ds_read_b64_tr_b16 v[74:75], v24 offset:23616
    s_waitcnt lgkmcnt(9)
    v_mfma_f32_32x32x16_bf16 v[176:191], v[60:63], v[36:39], v[176:191]
    ds_read_b128 v[52:55], v23 offset:16384
    ds_read_b64_tr_b16 v[76:77], v24 offset:25344
    ds_read_b64_tr_b16 v[78:79], v24 offset:25920
    s_waitcnt lgkmcnt(9)
    v_mfma_f32_32x32x16_bf16 v[176:191], v[64:67], v[40:43], v[176:191]
    s_waitcnt lgkmcnt(6)
    v_mfma_f32_32x32x16_bf16 v[176:191], v[68:71], v[44:47], v[176:191]
    s_waitcnt lgkmcnt(3)
    v_mfma_f32_32x32x16_bf16 v[176:191], v[72:75], v[48:51], v[176:191]
    s_waitcnt lgkmcnt(0)
    v_mfma_f32_32x32x16_bf16 v[176:191], v[76:79], v[52:55], v[176:191]
    v_add_u32 v20, 24576, v20
    v_add_u32 v21, 24576, v21
    v_add_u32 v22, 24576, v22
    v_add_u32 v23, 24576, v23
    v_add_u32 v24, 56480, v24
    v_mov_b32 v7, 163788
    s_mov_b32 s83, 200000
L_lw_8:
    ds_read_b32 v2, v7
    s_waitcnt lgkmcnt(0)
    v_readfirstlane_b32 s6, v2
    s_nop 0
    s_cmp_ge_u32 s6, 6
    s_cbranch_scc1 L_lw_8d
    s_sleep 1
    s_sub_u32 s83, s83, 1
    s_cmp_lg_u32 s83, 0
    s_cbranch_scc1 L_lw_8
L_lw_8d:
    ds_read_b128 v[32:35], v20 offset:0
    ds_read_b64_tr_b16 v[56:57], v24 offset:0
    ds_read_b64_tr_b16 v[58:59], v24 offset:576
    ds_read_b128 v[36:39], v21 offset:0
    ds_read_b64_tr_b16 v[60:61], v24 offset:2304
    ds_read_b64_tr_b16 v[62:63], v24 offset:2880
    ds_read_b128 v[40:43], v22 offset:0
    ds_read_b64_tr_b16 v[64:65], v24 offset:4608
    ds_read_b64_tr_b16 v[66:67], v24 offset:5184
    ds_read_b128 v[44:47], v23 offset:0
    ds_read_b64_tr_b16 v[68:69], v24 offset:6912
    ds_read_b64_tr_b16 v[70:71], v24 offset:7488
    s_waitcnt lgkmcnt(9)
    v_mfma_f32_32x32x16_bf16 v[176:191], v[56:59], v[32:35], v[176:191]
    ds_read_b128 v[48:51], v20 offset:8192
    ds_read_b64_tr_b16 v[72:73], v24 offset:9216
    ds_read_b64_tr_b16 v[74:75], v24 offset:9792
    s_waitcnt lgkmcnt(9)
    v_mfma_f32_32x32x16_bf16 v[176:191], v[60:63], v[36:39], v[176:191]
    ds_read_b128 v[52:55], v21 offset:8192
    ds_read_b64_tr_b16 v[76:77], v24 offset:11520
    ds_read_b64_tr_b16 v[78:79], v24 offset:12096
    s_waitcnt lgkmcnt(9)
    v_mfma_f32_32x32x16_bf16 v[176:191], v[64:67], v[40:43], v[176:191]
    ds_read_b128 v[32:35], v22 offset:8192
    ds_read_b64_tr_b16 v[56:57], v24 offset:13824
    ds_read_b64_tr_b16 v[58:59], v24 offset:14400
    s_waitcnt lgkmcnt(9)
    v_mfma_f32_32x32x16_bf16 v[176:191], v[68:71], v[44:47], v[176:191]
    ds_read_b128 v[36:39], v23 offset:8192
    ds_read_b64_tr_b16 v[60:61], v24 offset:16128
    ds_read_b64_tr_b16 v[62:63], v24 offset:16704
    s_waitcnt lgkmcnt(9)
    v_mfma_f32_32x32x16_bf16 v[176:191], v[72:75], v[48:51], v[176:191]
    ds_read_b128 v[40:43], v20 offset:16384
    ds_read_b64_tr_b16 v[64:65], v24 offset:18432
    ds_read_b64_tr_b16 v[66:67], v24 offset:19008
    s_waitcnt lgkmcnt(9)
    v_mfma_f32_32x32x16_bf16 v[176:191], v[76:79], v[52:55], v[176:191]
    ds_read_b128 v[44:47], v21 offset:16384
    ds_read_b64_tr_b16 v[68:69], v24 offset:20736
    ds_read_b64_tr_b16 v[70:71], v24 offset:21312
    s_waitcnt lgkmcnt(9)
    v_mfma_f32_32x32x16_bf16 v[176:191], v[56:59], v[32:35], v[176:191]
    ds_read_b128 v[48:51], v22 offset:16384
    ds_read_b64_tr_b16 v[72:73], v24 offset:23040
    ds_read_b64_tr_b16 v[74:75], v24 offset:23616
    s_waitcnt lgkmcnt(9)
    v_mfma_f32_32x32x16_bf16 v[176:191], v[60:63], v[36:39], v[176:191]
    ds_read_b128 v[52:55], v23 offset:16384
    ds_read_b64_tr_b16 v[76:77], v24 offset:25344
    ds_read_b64_tr_b16 v[78:79], v24 offset:25920
    s_waitcnt lgkmcnt(9)
    v_mfma_f32_32x32x16_bf16 v[176:191], v[64:67], v[40:43], v[176:191]
    s_waitcnt lgkmcnt(6)
    v_mfma_f32_32x32x16_bf16 v[176:191], v[68:71], v[44:47], v[176:191]
    s_waitcnt lgkmcnt(3)
    v_mfma_f32_32x32x16_bf16 v[176:191], v[72:75], v[48:51], v[176:191]
    s_waitcnt lgkmcnt(0)
    v_mfma_f32_32x32x16_bf16 v[176:191], v[76:79], v[52:55], v[176:191]
    ds_add_u32 v5, v13 offset:20
    v_add_u32 v20, 24576, v20
    v_add_u32 v21, 24576, v21
    v_add_u32 v22, 24576, v22
    v_add_u32 v23, 24576, v23
    v_add_u32 v24, 4294939056, v24
    v_mov_b32 v7, 163792
    s_mov_b32 s83, 200000
L_lw_9:
    ds_read_b32 v2, v7
    s_waitcnt lgkmcnt(0)
    v_readfirstlane_b32 s6, v2
    s_nop 0
    s_cmp_ge_u32 s6, 2
    s_cbranch_scc1 L_lw_9d
    s_sleep 1
    s_sub_u32 s83, s83, 1
    s_cmp_lg_u32 s83, 0
    s_cbranch_scc1 L_lw_9
L_lw_9d:
    ds_read_b128 v[32:35], v20 offset:0
    ds_read_b64_tr_b16 v[56:57], v24 offset:0
    ds_read_b64_tr_b16 v[58:59], v24 offset:576
    ds_read_b128 v[36:39], v21 offset:0
    ds_read_b64_tr_b16 v[60:61], v24 offset:2304
    ds_read_b64_tr_b16 v[62:63], v24 offset:2880
    ds_read_b128 v[40:43], v22 offset:0
    ds_read_b64_tr_b16 v[64:65], v24 offset:4608
    ds_read_b64_tr_b16 v[66:67], v24 offset:5184
    ds_read_b128 v[44:47], v23 offset:0
    ds_read_b64_tr_b16 v[68:69], v24 offset:6912
    ds_read_b64_tr_b16 v[70:71], v24 offset:7488
    s_waitcnt lgkmcnt(9)
    v_mfma_f32_32x32x16_bf16 v[176:191], v[56:59], v[32:35], v[176:191]
    ds_read_b128 v[48:51], v20 offset:8192
    ds_read_b64_tr_b16 v[72:73], v24 offset:9216
    ds_read_b64_tr_b16 v[74:75], v24 offset:9792
    s_waitcnt lgkmcnt(9)
    v_mfma_f32_32x32x16_bf16 v[176:191], v[60:63], v[36:39], v[176:191]
    ds_read_b128 v[52:55], v21 offset:8192
    ds_read_b64_tr_b16 v[76:77], v24 offset:11520
    ds_read_b64_tr_b16 v[78:79], v24 offset:12096
    s_waitcnt lgkmcnt(9)
    v_mfma_f32_32x32x16_bf16 v[176:191], v[64:67], v[40:43], v[176:191]
    ds_read_b128 v[32:35], v22 offset:8192
    ds_read_b64_tr_b16 v[56:57], v24 offset:13824
    ds_read_b64_tr_b16 v[58:59], v24 offset:14400
    s_waitcnt lgkmcnt(9)
    v_mfma_f32_32x32x16_bf16 v[176:191], v[68:71], v[44:47], v[176:191]
    ds_read_b128 v[36:39], v23 offset:8192
    ds_read_b64_tr_b16 v[60:61], v24 offset:16128
    ds_read_b64_tr_b16 v[62:63], v24 offset:16704
    s_waitcnt lgkmcnt(9)
    v_mfma_f32_32x32x16_bf16 v[176:191], v[72:75], v[48:51], v[176:191]
    ds_read_b128 v[40:43], v20 offset:16384
    ds_read_b64_tr_b16 v[64:65], v24 offset:18432
    ds_read_b64_tr_b16 v[66:67], v24 offset:19008
    s_waitcnt lgkmcnt(9)
    v_mfma_f32_32x32x16_bf16 v[176:191], v[76:79], v[52:55], v[176:191]
    ds_read_b128 v[44:47], v21 offset:16384
    ds_read_b64_tr_b16 v[68:69], v24 offset:20736
    ds_read_b64_tr_b16 v[70:71], v24 offset:21312
    s_waitcnt lgkmcnt(9)
    v_mfma_f32_32x32x16_bf16 v[176:191], v[56:59], v[32:35], v[176:191]
    ds_read_b128 v[48:51], v22 offset:16384
    ds_read_b64_tr_b16 v[72:73], v24 offset:23040
    ds_read_b64_tr_b16 v[74:75], v24 offset:23616
    s_waitcnt lgkmcnt(9)
    v_mfma_f32_32x32x16_bf16 v[176:191], v[60:63], v[36:39], v[176:191]
    ds_read_b128 v[52:55], v23 offset:16384
    ds_read_b64_tr_b16 v[76:77], v24 offset:25344
    ds_read_b64_tr_b16 v[78:79], v24 offset:25920
    s_waitcnt lgkmcnt(9)
    v_mfma_f32_32x32x16_bf16 v[176:191], v[64:67], v[40:43], v[176:191]
    s_waitcnt lgkmcnt(6)
    v_mfma_f32_32x32x16_bf16 v[176:191], v[68:71], v[44:47], v[176:191]
    s_waitcnt lgkmcnt(3)
    v_mfma_f32_32x32x16_bf16 v[176:191], v[72:75], v[48:51], v[176:191]
    s_waitcnt lgkmcnt(0)
    v_mfma_f32_32x32x16_bf16 v[176:191], v[76:79], v[52:55], v[176:191]
    v_mov_b32 v7, 163796
    s_mov_b32 s83, 200000
L_lw_10:
    ds_read_b32 v2, v7
    s_waitcnt lgkmcnt(0)
    v_readfirstlane_b32 s6, v2
    s_nop 0
    s_and_b32 s7, s6, 255
    s_cmp_ge_u32 s7, 6
    s_cbranch_scc1 L_lw_10d
    s_sleep 1
    s_sub_u32 s83, s83, 1
    s_cmp_lg_u32 s83, 0
    s_cbranch_scc1 L_lw_10
L_lw_10d:
L_dma0:
    s_load_dwordx2 s[40:41], s[0:1], 0
    s_mov_b32 s42, 2359296
    s_load_dwordx2 s[44:45], s[0:1], 8
    s_mov_b32 s46, 2359296
    s_load_dwordx2 s[48:49], s[0:1], 16
    s_mov_b32 s50, 2359296
    s_load_dwordx2 s[52:53], s[0:1], 24
    s_mov_b32 s54, 4608
    s_lshl_b32 s79, s3, 10
    s_add_u32 s79, s79, 32768
    s_cmp_lt_u32 s3, 4
    s_cselect_b32 s72, s32, s68
    s_cselect_b32 s73, s33, s69
    s_cselect_b32 s74, s34, s70
    s_mov_b32 s75, 0x20000
    s_cmp_ge_u32 s3, 6
    s_cbranch_scc1 L_ret4_k
    s_cmp_ge_u32 s3, 4
    s_cbranch_scc1 L_qdone
    buffer_load_ushort v216, v216, s[36:39], 0 offen
    buffer_load_ushort v217, v217, s[32:35], 0 offen
    buffer_load_dwordx4 v[212:215], v212, s[56:59], 0 offen
    s_mul_i32 s6, s5, 92160
    s_lshl_b32 s7, s22, 10
    s_add_u32 s6, s6, s7
    s_add_u32 s6, s6, 163840
    s_cmp_lt_u32 s22, 90
    s_cselect_b32 s78, s6, 0
    s_mov_b32 s6, 1051597459
    v_mul_f32 v176, s6, v176
    v_mul_f32 v177, s6, v177
    v_mul_f32 v178, s6, v178
    v_mul_f32 v179, s6, v179
    v_mul_f32 v180, s6, v180
    v_mul_f32 v181, s6, v181
    v_mul_f32 v182, s6, v182
    v_mul_f32 v183, s6, v183
    v_mul_f32 v184, s6, v184
    v_mul_f32 v185, s6, v185
    v_mul_f32 v186, s6, v186
    v_mul_f32 v187, s6, v187
    v_mul_f32 v188, s6, v188
    v_mul_f32 v189, s6, v189
    v_mul_f32 v190, s6, v190
    v_mul_f32 v191, s6, v191
    v_cvt_pk_bf16_f32 v32, v176, v177
    v_cvt_pk_bf16_f32 v33, v178, v179
    v_cvt_pk_bf16_f32 v34, v180, v181
    v_cvt_pk_bf16_f32 v35, v182, v183
    v_cvt_pk_bf16_f32 v36, v184, v185
    v_cvt_pk_bf16_f32 v37, v186, v187
    v_cvt_pk_bf16_f32 v38, v188, v189
    v_cvt_pk_bf16_f32 v39, v190, v191
    s_cmp_eq_u32 s11, 1
    s_cbranch_scc1 L_qw1
    ds_write_b32 v17, v32 offset:0
    ds_write_b32 v17, v33 offset:4
    ds_write_b32 v17, v34 offset:16
    ds_write_b32 v17, v35 offset:20
    ds_write_b32 v18, v36 offset:32
    ds_write_b32 v17, v37 offset:48
    ds_write_b32 v17, v38 offset:60
    ds_write_b32 v17, v39 offset:64
    s_branch L_qdone
L_qw1:
    ds_write_b32 v18, v32 offset:76
    ds_write_b32 v18, v33 offset:80
    ds_write_b32 v17, v34 offset:104
    ds_write_b32 v17, v35 offset:108
    ds_write_b32 v17, v36 offset:120
    ds_write_b32 v18, v37 offset:124
    ds_write_b32 v17, v38 offset:148
    ds_write_b32 v17, v39 offset:152
L_qdone:
    s_mul_i32 s6, s3, 9216
    s_add_u32 s39, s6, 61440
    s_mul_i32 s100, s4, 73728
    s_add_u32 s100, s100, s6
    s_add_u32 s100, s100, 5636096
    s_and_b32 s10, s3, 3
    s_lshr_b32 s11, s3, 2
    s_mul_i32 s7, s11, 9216
    s_add_u32 s7, s7, 61440
    s_mul_i32 s9, s11, 19456
    s_lshl_b32 s6, s10, 6
    s_add_u32 s9, s9, s6
    s_add_u32 s6, s10, 0
    s_and_b32 s6, s6, 3
    s_mul_i32 s8, s6, 18432
    s_add_u32 s56, s8, s7
    s_mul_i32 s8, s6, 4864
    s_add_u32 s32, s8, s9
    s_add_u32 s6, s10, 1
    s_and_b32 s6, s6, 3
    s_mul_i32 s8, s6, 18432
    s_add_u32 s57, s8, s7
    s_mul_i32 s8, s6, 4864
    s_add_u32 s33, s8, s9
    s_add_u32 s6, s10, 2
    s_and_b32 s6, s6, 3
    s_mul_i32 s8, s6, 18432
    s_add_u32 s58, s8, s7
    s_mul_i32 s8, s6, 4864
    s_add_u32 s34, s8, s9
    s_add_u32 s6, s10, 3
    s_and_b32 s6, s6, 3
    s_mul_i32 s8, s6, 18432
    s_add_u32 s59, s8, s7
    s_mul_i32 s8, s6, 4864
    s_add_u32 s35, s8, s9
    s_lshl_b32 s6, s10, 6
    s_sub_u32 s36, s32, s6
    s_mul_i32 s6, s10, 4864
    s_lshl_b32 s7, s11, 7
    s_add_u32 s38, s6, s7
    s_mul_i32 s37, s5, 294912
    s_lshl_b32 s6, s4, 7
    s_add_u32 s37, s37, s6
    s_add_u32 s37, s37, 3276800
    s_lshl_b32 s6, s11, 17
    s_lshl_b32 s7, s10, 5
    s_add_u32 s6, s6, s7
    s_add_u32 s101, s6, s37
    s_add_u32 s37, s37, 262144
    s_mul_i32 s82, s4, 4608
    s_mul_i32 s7, s5, 576
    s_add_u32 s82, s82, s7
    s_add_u32 s82, s82, 7995392
    s_cmp_eq_u32 s4, 0
    s_cselect_b32 s82, 0x40000000, s82
    s_lshl_b32 s7, s11, 8
    s_add_u32 s81, s82, s7
    s_add_u32 s82, s82, 512
    s_cmp_eq_u32 s10, 0
    s_cselect_b32 s81, s81, 0x40000000
    s_lshl_b32 s6, s3, 10
    s_add_u32 s22, s6, 135168
    s_cmp_lt_u32 s3, 4
    s_cbranch_scc1 L_q5
    s_waitcnt vmcnt(0)
L_q5:
    s_waitcnt lgkmcnt(0)
    s_barrier
    ds_read_b128 v[112:115], v112
    ds_read_b128 v[116:119], v116
    ds_read_b32 v120, v120
    ds_read_b32 v123, v123
    s_setprio 3
    ds_read_b128 v[132:135], v158
    ds_read_b128 v[124:127], v157
    ds_read_b128 v[128:131], v157 offset:1024
    s_mov_b64 exec, s[76:77]
    ds_read_b128 v[140:143], v159
    ds_read_b128 v[144:147], v159 offset:576
    s_mov_b64 exec, -1
    s_waitcnt lgkmcnt(4)
    v_mfma_f32_32x32x4_2b_bf16 v[16:47], v[132:133], v[120:121], 4.0
    s_add_u32 s79, s79, 8192
    s_mov_b32 m0, s79
    s_nop 0
    buffer_load_dwordx4 v14, s[68:71], s79 offen sc1 lds
    s_add_u32 s79, s79, 8192
    s_mov_b32 m0, s79
    s_nop 0
    buffer_load_dwordx4 v14, s[68:71], s79 offen sc1 lds
    s_add_u32 s79, s79, 8192
    s_mov_b32 m0, s79
    s_nop 0
    buffer_load_dwordx4 v14, s[68:71], s79 offen sc1 lds
    s_add_u32 s79, s79, 8192
    s_mov_b32 m0, s79
    s_nop 0
    buffer_load_dwordx4 v14, s[68:71], s79 offen sc1 lds
    s_waitcnt lgkmcnt(0)
    s_nop 0
    v_mfma_f32_32x32x16_bf16 v[16:31], v[124:127], v[112:115], v[16:31]
    v_mfma_f32_32x32x16_bf16 v[32:47], v[124:127], v[116:119], v[32:47]
    s_setprio 3
    s_nop 9
    v_exp_f32 v16, v16
    v_exp_f32 v17, v17
    v_exp_f32 v18, v18
    v_exp_f32 v19, v19
    v_exp_f32 v20, v20
    s_waitcnt lgkmcnt(0)
    s_mov_b64 exec, s[76:77]
    ds_read_b128 v[148:151], v159 offset:1152
    ds_read_b128 v[152:155], v159 offset:1728
    s_mov_b64 exec, -1
    ds_read_b128 v[124:127], v157 offset:2048
    ds_read_b128 v[136:139], v158 offset:512
    v_mfma_f32_32x32x4_2b_bf16 v[48:79], v[132:133], v[122:123], 4.0
    v_exp_f32 v21, v21
    v_exp_f32 v22, v22
    v_exp_f32 v23, v23
    v_exp_f32 v24, v24
    v_exp_f32 v25, v25
    v_exp_f32 v26, v26
    v_exp_f32 v27, v27
    v_exp_f32 v28, v28
    v_smfmac_f32_32x32x32_bf16 v[80:95], v[140:143], v[16:23], v156
    v_exp_f32 v29, v29
    v_exp_f32 v30, v30
    v_exp_f32 v31, v31
    v_exp_f32 v32, v32
    v_exp_f32 v33, v33
    v_smfmac_f32_32x32x32_bf16 v[80:95], v[144:147], v[24:31], v156
    v_exp_f32 v34, v34
    v_exp_f32 v35, v35
    v_exp_f32 v36, v36
    v_exp_f32 v37, v37
    v_mfma_f32_32x32x16_bf16 v[48:63], v[128:131], v[112:115], v[48:63]
    v_exp_f32 v38, v38
    v_exp_f32 v39, v39
    v_exp_f32 v40, v40
    v_exp_f32 v41, v41
    v_smfmac_f32_32x32x32_bf16 v[96:111], v[140:143], v[32:39], v156
    v_exp_f32 v42, v42
    v_exp_f32 v43, v43
    v_exp_f32 v44, v44
    v_mfma_f32_32x32x16_bf16 v[64:79], v[128:131], v[116:119], v[64:79]
    v_exp_f32 v45, v45
    v_exp_f32 v46, v46
    v_exp_f32 v47, v47
    v_exp_f32 v48, v48
    v_exp_f32 v49, v49
    v_smfmac_f32_32x32x32_bf16 v[96:111], v[144:147], v[40:47], v156
    v_exp_f32 v50, v50
    v_exp_f32 v51, v51
    v_exp_f32 v52, v52
    s_waitcnt lgkmcnt(0)
    s_mov_b64 exec, s[76:77]
    ds_read_b128 v[140:143], v159 offset:2304
    ds_read_b128 v[144:147], v159 offset:2880
    s_mov_b64 exec, -1
    ds_read_b128 v[128:131], v157 offset:3072
    v_mfma_f32_32x32x4_2b_bf16 v[16:47], v[134:135], v[120:121], 4.0
    v_exp_f32 v53, v53
    v_exp_f32 v54, v54
    v_exp_f32 v55, v55
    v_exp_f32 v56, v56
    s_cmp_lt_u32 s3, 4
    s_cbranch_scc1 L_sideK
L_sideKret:
    v_exp_f32 v57, v57
    v_exp_f32 v58, v58
    v_exp_f32 v59, v59
    v_exp_f32 v60, v60
    v_smfmac_f32_32x32x32_bf16 v[80:95], v[148:151], v[48:55], v156
    v_exp_f32 v61, v61
    v_exp_f32 v62, v62
    v_exp_f32 v63, v63
    s_setprio 2
    v_exp_f32 v64, v64
    v_exp_f32 v65, v65
    v_smfmac_f32_32x32x32_bf16 v[80:95], v[152:155], v[56:63], v156
    v_exp_f32 v66, v66
    v_exp_f32 v67, v67
    s_mov_b32 m0, s23
    s_nop 0
    buffer_load_dwordx4 v242, s[44:47], 0 offen nt lds
    v_exp_f32 v68, v68
    v_exp_f32 v69, v69
    v_mfma_f32_32x32x16_bf16 v[16:31], v[124:127], v[112:115], v[16:31]
    v_exp_f32 v70, v70
    v_exp_f32 v71, v71
    v_exp_f32 v72, v72
    v_exp_f32 v73, v73
    v_smfmac_f32_32x32x32_bf16 v[96:111], v[148:151], v[64:71], v156
    v_exp_f32 v74, v74
    v_exp_f32 v75, v75
    v_exp_f32 v76, v76
    v_mfma_f32_32x32x16_bf16 v[32:47], v[124:127], v[116:119], v[32:47]
    v_exp_f32 v77, v77
    v_exp_f32 v78, v78
    v_exp_f32 v79, v79
    v_exp_f32 v16, v16
    v_exp_f32 v17, v17
    v_smfmac_f32_32x32x32_bf16 v[96:111], v[152:155], v[72:79], v156
    v_exp_f32 v18, v18
    v_exp_f32 v19, v19
    v_exp_f32 v20, v20
    s_waitcnt lgkmcnt(0)
    s_mov_b64 exec, s[76:77]
    ds_read_b128 v[148:151], v159 offset:3456
    ds_read_b128 v[152:155], v159 offset:4032
    s_mov_b64 exec, -1
    ds_read_b128 v[124:127], v157 offset:4096
    v_mfma_f32_32x32x4_2b_bf16 v[48:79], v[134:135], v[122:123], 4.0
    v_exp_f32 v21, v21
    v_exp_f32 v22, v22
    v_exp_f32 v23, v23
    v_exp_f32 v24, v24
    s_add_u32 m0, s23, 10096
    s_nop 0
    buffer_load_dwordx4 v241, s[48:51], 0 offen nt lds
    v_exp_f32 v25, v25
    v_exp_f32 v26, v26
    v_exp_f32 v27, v27
    v_exp_f32 v28, v28
    v_smfmac_f32_32x32x32_bf16 v[80:95], v[140:143], v[16:23], v156
    v_exp_f32 v29, v29
    v_exp_f32 v30, v30
    v_exp_f32 v31, v31
    s_setprio 1
    v_exp_f32 v32, v32
    v_exp_f32 v33, v33
    v_smfmac_f32_32x32x32_bf16 v[80:95], v[144:147], v[24:31], v156
    v_exp_f32 v34, v34
    v_exp_f32 v35, v35
    buffer_load_dwordx4 v[228:231], v246, s[52:55], 0 offen
    v_exp_f32 v36, v36
    v_exp_f32 v37, v37
    v_mfma_f32_32x32x16_bf16 v[48:63], v[128:131], v[112:115], v[48:63]
    v_exp_f32 v38, v38
    v_exp_f32 v39, v39
    v_exp_f32 v40, v40
    v_exp_f32 v41, v41
    v_smfmac_f32_32x32x32_bf16 v[96:111], v[140:143], v[32:39], v156
    v_exp_f32 v42, v42
    v_exp_f32 v43, v43
    v_exp_f32 v44, v44
    v_mfma_f32_32x32x16_bf16 v[64:79], v[128:131], v[116:119], v[64:79]
    v_exp_f32 v45, v45
    v_exp_f32 v46, v46
    v_exp_f32 v47, v47
    v_exp_f32 v48, v48
    v_exp_f32 v49, v49
    v_smfmac_f32_32x32x32_bf16 v[96:111], v[144:147], v[40:47], v156
    v_exp_f32 v50, v50
    v_exp_f32 v51, v51
    v_exp_f32 v52, v52
    s_waitcnt lgkmcnt(0)
    s_mov_b64 exec, s[76:77]
    ds_read_b128 v[140:143], v159 offset:4608
    ds_read_b128 v[144:147], v159 offset:5184
    s_mov_b64 exec, -1
    ds_read_b128 v[128:131], v157 offset:5120
    v_mfma_f32_32x32x4_2b_bf16 v[16:47], v[136:137], v[120:121], 4.0
    v_exp_f32 v53, v53
    v_exp_f32 v54, v54
    v_exp_f32 v55, v55
    v_exp_f32 v56, v56
    v_exp_f32 v57, v57
    s_setprio 0
    v_exp_f32 v58, v58
    v_exp_f32 v59, v59
    v_exp_f32 v60, v60
    v_smfmac_f32_32x32x32_bf16 v[80:95], v[148:151], v[48:55], v156
    v_exp_f32 v61, v61
    v_exp_f32 v62, v62
    v_exp_f32 v63, v63
    v_exp_f32 v64, v64
    v_exp_f32 v65, v65
    v_smfmac_f32_32x32x32_bf16 v[80:95], v[152:155], v[56:63], v156
    v_exp_f32 v66, v66
    v_exp_f32 v67, v67
    v_exp_f32 v68, v68
    v_exp_f32 v69, v69
    v_mfma_f32_32x32x16_bf16 v[16:31], v[124:127], v[112:115], v[16:31]
    v_exp_f32 v70, v70
    v_exp_f32 v71, v71
    v_exp_f32 v72, v72
    v_exp_f32 v73, v73
    v_smfmac_f32_32x32x32_bf16 v[96:111], v[148:151], v[64:71], v156
    v_exp_f32 v74, v74
    v_exp_f32 v75, v75
    v_exp_f32 v76, v76
    v_mfma_f32_32x32x16_bf16 v[32:47], v[124:127], v[116:119], v[32:47]
    v_exp_f32 v77, v77
    v_exp_f32 v78, v78
    v_exp_f32 v79, v79
    s_setprio 3
    s_waitcnt vmcnt(3)
    s_barrier
    v_exp_f32 v16, v16
    v_exp_f32 v17, v17
    v_smfmac_f32_32x32x32_bf16 v[96:111], v[152:155], v[72:79], v156
    v_exp_f32 v18, v18
    v_exp_f32 v19, v19
    v_exp_f32 v20, v20
    s_waitcnt lgkmcnt(0)
    s_mov_b64 exec, s[76:77]
    ds_read_b128 v[148:151], v159 offset:5760
    ds_read_b128 v[152:155], v159 offset:6336
    s_mov_b64 exec, -1
    ds_read_b128 v[124:127], v157 offset:6144
    ds_read_b128 v[132:135], v158 offset:36864
    v_mfma_f32_32x32x4_2b_bf16 v[48:79], v[136:137], v[122:123], 4.0
    v_exp_f32 v21, v21
    v_exp_f32 v22, v22
    v_exp_f32 v23, v23
    v_exp_f32 v24, v24
    s_add_u32 s79, s79, 8192
    s_mov_b32 m0, s79
    s_nop 0
    buffer_load_dwordx4 v14, s[68:71], s79 offen sc1 lds
    v_exp_f32 v25, v25
    v_exp_f32 v26, v26
    v_exp_f32 v27, v27
    v_exp_f32 v28, v28
    v_smfmac_f32_32x32x32_bf16 v[80:95], v[140:143], v[16:23], v156
    v_exp_f32 v29, v29
    v_exp_f32 v30, v30
    v_exp_f32 v31, v31
    v_exp_f32 v32, v32
    v_exp_f32 v33, v33
    v_smfmac_f32_32x32x32_bf16 v[80:95], v[144:147], v[24:31], v156
    v_exp_f32 v34, v34
    v_exp_f32 v35, v35
    s_add_u32 s79, s79, 8192
    s_mov_b32 m0, s79
    s_nop 0
    buffer_load_dwordx4 v14, s[68:71], s79 offen sc1 lds
    v_exp_f32 v36, v36
    v_exp_f32 v37, v37
    v_mfma_f32_32x32x16_bf16 v[48:63], v[128:131], v[112:115], v[48:63]
    v_exp_f32 v38, v38
    v_exp_f32 v39, v39
    v_exp_f32 v40, v40
    v_exp_f32 v41, v41
    v_smfmac_f32_32x32x32_bf16 v[96:111], v[140:143], v[32:39], v156
    v_exp_f32 v42, v42
    v_exp_f32 v43, v43
    v_exp_f32 v44, v44
    v_mfma_f32_32x32x16_bf16 v[64:79], v[128:131], v[116:119], v[64:79]
    v_exp_f32 v45, v45
    v_exp_f32 v46, v46
    v_exp_f32 v47, v47
    v_exp_f32 v48, v48
    v_exp_f32 v49, v49
    v_smfmac_f32_32x32x32_bf16 v[96:111], v[144:147], v[40:47], v156
    v_exp_f32 v50, v50
    v_exp_f32 v51, v51
    v_exp_f32 v52, v52
    s_waitcnt lgkmcnt(0)
    s_mov_b64 exec, s[76:77]
    ds_read_b128 v[140:143], v159 offset:6912
    ds_read_b128 v[144:147], v159 offset:7488
    s_mov_b64 exec, -1
    ds_read_b128 v[128:131], v157 offset:7168
    v_mfma_f32_32x32x4_2b_bf16 v[16:47], v[138:139], v[120:121], 4.0
    v_exp_f32 v53, v53
    v_exp_f32 v54, v54
    v_exp_f32 v55, v55
    v_exp_f32 v56, v56
    s_add_u32 s79, s79, 8192
    s_mov_b32 m0, s79
    s_nop 0
    buffer_load_dwordx4 v14, s[68:71], s79 offen sc1 lds
    v_exp_f32 v57, v57
    v_exp_f32 v58, v58
    v_exp_f32 v59, v59
    v_exp_f32 v60, v60
    v_smfmac_f32_32x32x32_bf16 v[80:95], v[148:151], v[48:55], v156
    v_exp_f32 v61, v61
    v_exp_f32 v62, v62
    v_exp_f32 v63, v63
    s_setprio 2
    s_add_u32 s79, s79, 8192
    s_mov_b32 m0, s79
    s_nop 0
    buffer_load_dwordx4 v14, s[68:71], s79 offen sc1 lds
    v_exp_f32 v64, v64
    v_exp_f32 v65, v65
    v_smfmac_f32_32x32x32_bf16 v[80:95], v[152:155], v[56:63], v156
    v_exp_f32 v66, v66
    v_exp_f32 v67, v67
    v_exp_f32 v68, v68
    v_exp_f32 v69, v69
    v_mfma_f32_32x32x16_bf16 v[16:31], v[124:127], v[112:115], v[16:31]
    v_exp_f32 v70, v70
    v_exp_f32 v71, v71
    s_add_u32 s79, s79, 8192
    s_mov_b32 m0, s79
    s_nop 0
    buffer_load_dwordx4 v14, s[68:71], s79 offen sc1 lds
    v_exp_f32 v72, v72
    v_exp_f32 v73, v73
    v_smfmac_f32_32x32x32_bf16 v[96:111], v[148:151], v[64:71], v156
    v_exp_f32 v74, v74
    v_exp_f32 v75, v75
    v_exp_f32 v76, v76
    v_mfma_f32_32x32x16_bf16 v[32:47], v[124:127], v[116:119], v[32:47]
    v_exp_f32 v77, v77
    v_exp_f32 v78, v78
    v_exp_f32 v79, v79
    v_exp_f32 v16, v16
    v_exp_f32 v17, v17
    v_smfmac_f32_32x32x32_bf16 v[96:111], v[152:155], v[72:79], v156
    v_exp_f32 v18, v18
    v_exp_f32 v19, v19
    v_exp_f32 v20, v20
    s_waitcnt lgkmcnt(0)
    s_mov_b64 exec, s[76:77]
    ds_read_b128 v[148:151], v159 offset:8064
    ds_read_b128 v[152:155], v159 offset:8640
    s_mov_b64 exec, -1
    ds_read_b128 v[124:127], v157 offset:36864
    v_mfma_f32_32x32x4_2b_bf16 v[48:79], v[138:139], v[122:123], 4.0
    v_exp_f32 v21, v21
    v_exp_f32 v22, v22
    v_exp_f32 v23, v23
    v_exp_f32 v24, v24
    s_add_u32 s79, s79, 8192
    s_mov_b32 m0, s79
    s_nop 0
    buffer_load_dwordx4 v14, s[68:71], s79 offen sc1 lds
    v_exp_f32 v25, v25
    v_exp_f32 v26, v26
    v_exp_f32 v27, v27
    v_exp_f32 v28, v28
    v_smfmac_f32_32x32x32_bf16 v[80:95], v[140:143], v[16:23], v156
    v_exp_f32 v29, v29
    v_exp_f32 v30, v30
    v_exp_f32 v31, v31
    s_setprio 1
    v_exp_f32 v32, v32
    v_exp_f32 v33, v33
    v_smfmac_f32_32x32x32_bf16 v[80:95], v[144:147], v[24:31], v156
    v_exp_f32 v34, v34
    v_exp_f32 v35, v35
    v_exp_f32 v36, v36
    v_exp_f32 v37, v37
    v_mfma_f32_32x32x16_bf16 v[48:63], v[128:131], v[112:115], v[48:63]
    v_exp_f32 v38, v38
    v_exp_f32 v39, v39
    v_exp_f32 v40, v40
    v_exp_f32 v41, v41
    v_smfmac_f32_32x32x32_bf16 v[96:111], v[140:143], v[32:39], v156
    v_exp_f32 v42, v42
    v_exp_f32 v43, v43
    v_exp_f32 v44, v44
    v_mfma_f32_32x32x16_bf16 v[64:79], v[128:131], v[116:119], v[64:79]
    v_exp_f32 v45, v45
    v_exp_f32 v46, v46
    v_exp_f32 v47, v47
    v_exp_f32 v48, v48
    v_exp_f32 v49, v49
    v_smfmac_f32_32x32x32_bf16 v[96:111], v[144:147], v[40:47], v156
    v_exp_f32 v50, v50
    v_exp_f32 v51, v51
    v_exp_f32 v52, v52
    s_waitcnt lgkmcnt(0)
    s_mov_b64 exec, s[76:77]
    ds_read_b128 v[140:143], v159 offset:36864
    ds_read_b128 v[144:147], v159 offset:37440
    s_mov_b64 exec, -1
    ds_read_b128 v[128:131], v157 offset:37888
    v_mfma_f32_32x32x4_2b_bf16 v[16:47], v[132:133], v[120:121], 4.0
    v_exp_f32 v53, v53
    v_exp_f32 v54, v54
    v_exp_f32 v55, v55
    v_add_u32 v157, 36864, v157
    v_add_u32 v159, 36864, v159
    v_add_u32 v158, 36864, v158
    v_exp_f32 v56, v56
    buffer_store_dwordx4 v[248:251], v14, s[68:71], s31 offen sc1
    v_exp_f32 v57, v57
    s_setprio 0
    v_exp_f32 v58, v58
    v_exp_f32 v59, v59
    v_exp_f32 v60, v60
    v_smfmac_f32_32x32x32_bf16 v[80:95], v[148:151], v[48:55], v156
    v_exp_f32 v61, v61
    v_exp_f32 v62, v62
    v_exp_f32 v63, v63
    v_exp_f32 v64, v64
    v_exp_f32 v65, v65
    v_smfmac_f32_32x32x32_bf16 v[80:95], v[152:155], v[56:63], v156
    v_exp_f32 v66, v66
    v_exp_f32 v67, v67
    v_exp_f32 v68, v68
    v_exp_f32 v69, v69
    v_mfma_f32_32x32x16_bf16 v[16:31], v[124:127], v[112:115], v[16:31]
    v_exp_f32 v70, v70
    v_exp_f32 v71, v71
    v_exp_f32 v72, v72
    v_exp_f32 v73, v73
    v_smfmac_f32_32x32x32_bf16 v[96:111], v[148:151], v[64:71], v156
    v_exp_f32 v74, v74
    v_exp_f32 v75, v75
    v_exp_f32 v76, v76
    v_mfma_f32_32x32x16_bf16 v[32:47], v[124:127], v[116:119], v[32:47]
    v_exp_f32 v77, v77
    v_exp_f32 v78, v78
    v_exp_f32 v79, v79
    s_setprio 3
    s_waitcnt vmcnt(2)
    s_barrier
    v_exp_f32 v16, v16
    s_cmp_ge_u32 s3, 4
    s_cselect_b64 s[12:13], -1, 0
    v_exp_f32 v17, v17
    v_smfmac_f32_32x32x32_bf16 v[96:111], v[152:155], v[72:79], v156
    v_exp_f32 v18, v18
    v_exp_f32 v19, v19
    v_exp_f32 v20, v20
    s_waitcnt lgkmcnt(0)
    s_mov_b64 exec, s[76:77]
    ds_read_b128 v[148:151], v159 offset:1152
    ds_read_b128 v[152:155], v159 offset:1728
    s_mov_b64 exec, -1
    ds_read_b128 v[124:127], v157 offset:2048
    ds_read_b128 v[136:139], v158 offset:512
    v_mfma_f32_32x32x4_2b_bf16 v[48:79], v[132:133], v[122:123], 4.0
    v_exp_f32 v21, v21
    v_exp_f32 v22, v22
    v_exp_f32 v23, v23
    ds_read2_b32 v[208:209], v243 offset0:0 offset1:36
    v_exp_f32 v24, v24
    buffer_store_dwordx4 v[248:251], v206, s[68:71], 0 offen sc1
    v_exp_f32 v25, v25
    v_exp_f32 v26, v26
    v_exp_f32 v27, v27
    ds_read2_b32 v[210:211], v243 offset0:72 offset1:108
    v_exp_f32 v28, v28
    v_smfmac_f32_32x32x32_bf16 v[80:95], v[140:143], v[16:23], v156
    v_exp_f32 v29, v29
    v_exp_f32 v30, v30
    v_exp_f32 v31, v31
    ds_read2_b32 v[220:221], v245 offset0:0 offset1:36
    v_exp_f32 v32, v32
    v_exp_f32 v33, v33
    v_smfmac_f32_32x32x32_bf16 v[80:95], v[144:147], v[24:31], v156
    v_exp_f32 v34, v34
    v_exp_f32 v35, v35
    v_exp_f32 v36, v36
    s_mov_b64 exec, s[12:13]
    ds_read2_b32 v[212:213], v243 offset0:144 offset1:180
    ds_read2_b32 v[214:215], v243 offset0:216 offset1:252
    s_mov_b64 exec, -1
    v_exp_f32 v37, v37
    v_mfma_f32_32x32x16_bf16 v[48:63], v[128:131], v[112:115], v[48:63]
    v_exp_f32 v38, v38
    v_exp_f32 v39, v39
    v_exp_f32 v40, v40
    v_exp_f32 v41, v41
    v_smfmac_f32_32x32x32_bf16 v[96:111], v[140:143], v[32:39], v156
    v_exp_f32 v42, v42
    v_exp_f32 v43, v43
    v_exp_f32 v44, v44
    v_mfma_f32_32x32x16_bf16 v[64:79], v[128:131], v[116:119], v[64:79]
    v_exp_f32 v45, v45
    v_exp_f32 v46, v46
    v_exp_f32 v47, v47
    v_exp_f32 v48, v48
    v_exp_f32 v49, v49
    v_smfmac_f32_32x32x32_bf16 v[96:111], v[144:147], v[40:47], v156
    v_exp_f32 v50, v50
    v_exp_f32 v51, v51
    v_exp_f32 v52, v52
    s_waitcnt lgkmcnt(0)
    s_mov_b64 exec, s[76:77]
    ds_read_b128 v[140:143], v159 offset:2304
    ds_read_b128 v[144:147], v159 offset:2880
    s_mov_b64 exec, -1
    ds_read_b128 v[128:131], v157 offset:3072
    v_mfma_f32_32x32x4_2b_bf16 v[16:47], v[134:135], v[120:121], 4.0
    v_exp_f32 v53, v53
    v_exp_f32 v54, v54
    v_exp_f32 v55, v55
    s_mov_b64 exec, s[12:13]
    ds_read2_b32 v[216:217], v244 offset0:0 offset1:36
    ds_read2_b32 v[218:219], v244 offset0:72 offset1:108
    s_mov_b64 exec, -1
    v_exp_f32 v56, v56
    buffer_store_dwordx4 v[248:251], v207, s[68:71], 0 offen sc1
    v_exp_f32 v57, v57
    v_exp_f32 v58, v58
    v_exp_f32 v59, v59
    v_exp_f32 v60, v60
    v_smfmac_f32_32x32x32_bf16 v[80:95], v[148:151], v[48:55], v156
    v_exp_f32 v61, v61
    v_exp_f32 v62, v62
    s_mov_b64 exec, s[12:13]
    ds_read2_b32 v[222:223], v245 offset0:72 offset1:108
    ds_read2_b32 v[224:225], v245 offset0:144 offset1:180
    s_mov_b64 exec, -1
    v_exp_f32 v63, v63
    v_exp_f32 v64, v64
    v_exp_f32 v65, v65
    v_smfmac_f32_32x32x32_bf16 v[80:95], v[152:155], v[56:63], v156
    v_exp_f32 v66, v66
    v_exp_f32 v67, v67
    v_exp_f32 v68, v68
    s_mov_b64 exec, s[12:13]
    ds_read2_b32 v[226:227], v245 offset0:216 offset1:252
    s_mov_b64 exec, -1
    v_exp_f32 v69, v69
    v_mfma_f32_32x32x16_bf16 v[16:31], v[124:127], v[112:115], v[16:31]
    v_exp_f32 v70, v70
    v_exp_f32 v71, v71
    v_exp_f32 v72, v72
    v_exp_f32 v73, v73
    v_smfmac_f32_32x32x32_bf16 v[96:111], v[148:151], v[64:71], v156
    v_exp_f32 v74, v74
    v_exp_f32 v75, v75
    v_exp_f32 v76, v76
    v_mfma_f32_32x32x16_bf16 v[32:47], v[124:127], v[116:119], v[32:47]
    v_exp_f32 v77, v77
    v_exp_f32 v78, v78
    v_exp_f32 v79, v79
    v_exp_f32 v16, v16
    v_exp_f32 v17, v17
    v_smfmac_f32_32x32x32_bf16 v[96:111], v[152:155], v[72:79], v156
    v_exp_f32 v18, v18
    v_exp_f32 v19, v19
    v_exp_f32 v20, v20
    s_waitcnt lgkmcnt(0)
    s_mov_b64 exec, s[76:77]
    ds_read_b128 v[148:151], v159 offset:3456
    ds_read_b128 v[152:155], v159 offset:4032
    s_mov_b64 exec, -1
    ds_read_b128 v[124:127], v157 offset:4096
    v_mfma_f32_32x32x4_2b_bf16 v[48:79], v[134:135], v[122:123], 4.0
    v_exp_f32 v21, v21
    s_branch L_sideB
L_sideBret:
    v_exp_f32 v22, v22
    v_exp_f32 v23, v23
    v_exp_f32 v24, v24
    v_exp_f32 v25, v25
    v_exp_f32 v26, v26
    v_exp_f32 v27, v27
    v_exp_f32 v28, v28
    v_smfmac_f32_32x32x32_bf16 v[80:95], v[140:143], v[16:23], v156
    v_exp_f32 v29, v29
    v_exp_f32 v30, v30
    v_exp_f32 v31, v31
    v_exp_f32 v32, v32
    v_exp_f32 v33, v33
    v_smfmac_f32_32x32x32_bf16 v[80:95], v[144:147], v[24:31], v156
    v_exp_f32 v34, v34
    v_exp_f32 v35, v35
    v_exp_f32 v36, v36
    v_exp_f32 v37, v37
    v_mfma_f32_32x32x16_bf16 v[48:63], v[128:131], v[112:115], v[48:63]
    v_exp_f32 v38, v38
    v_exp_f32 v39, v39
    v_exp_f32 v40, v40
    v_exp_f32 v41, v41
    v_smfmac_f32_32x32x32_bf16 v[96:111], v[140:143], v[32:39], v156
    v_exp_f32 v42, v42
    v_exp_f32 v43, v43
    v_exp_f32 v44, v44
    v_mfma_f32_32x32x16_bf16 v[64:79], v[128:131], v[116:119], v[64:79]
    v_exp_f32 v45, v45
    v_exp_f32 v46, v46
    v_exp_f32 v47, v47
    v_exp_f32 v48, v48
    v_exp_f32 v49, v49
    v_smfmac_f32_32x32x32_bf16 v[96:111], v[144:147], v[40:47], v156
    v_exp_f32 v50, v50
    v_exp_f32 v51, v51
    v_exp_f32 v52, v52
    s_waitcnt lgkmcnt(0)
    s_mov_b64 exec, s[76:77]
    ds_read_b128 v[140:143], v159 offset:4608
    ds_read_b128 v[144:147], v159 offset:5184
    s_mov_b64 exec, -1
    ds_read_b128 v[128:131], v157 offset:5120
    v_mfma_f32_32x32x4_2b_bf16 v[16:47], v[136:137], v[120:121], 4.0
    v_exp_f32 v53, v53
    v_exp_f32 v54, v54
    v_exp_f32 v55, v55
    v_exp_f32 v56, v56
    v_exp_f32 v57, v57
    v_exp_f32 v58, v58
    v_exp_f32 v59, v59
    v_exp_f32 v60, v60
    v_smfmac_f32_32x32x32_bf16 v[80:95], v[148:151], v[48:55], v156
    v_exp_f32 v61, v61
    v_exp_f32 v62, v62
    v_exp_f32 v63, v63
    buffer_load_dwordx4 v[244:247], v238, s[40:43], 0 offen nt
    v_exp_f32 v64, v64
    v_exp_f32 v65, v65
    v_smfmac_f32_32x32x32_bf16 v[80:95], v[152:155], v[56:63], v156
    v_exp_f32 v66, v66
    v_exp_f32 v67, v67
    v_exp_f32 v68, v68
    v_exp_f32 v69, v69
    v_mfma_f32_32x32x16_bf16 v[16:31], v[124:127], v[112:115], v[16:31]
    v_exp_f32 v70, v70
    v_exp_f32 v71, v71
    v_exp_f32 v72, v72
    v_exp_f32 v73, v73
    v_smfmac_f32_32x32x32_bf16 v[96:111], v[148:151], v[64:71], v156
    v_exp_f32 v74, v74
    v_exp_f32 v75, v75
    v_exp_f32 v76, v76
    v_mfma_f32_32x32x16_bf16 v[32:47], v[124:127], v[116:119], v[32:47]
    v_exp_f32 v77, v77
    v_exp_f32 v78, v78
    v_exp_f32 v79, v79
    v_exp_f32 v16, v16
    s_waitcnt vmcnt(1)
    ds_add_rtn_u32 v4, v5, v13 offset:28
    v_exp_f32 v17, v17
    v_smfmac_f32_32x32x32_bf16 v[96:111], v[152:155], v[72:79], v156
    v_exp_f32 v18, v18
    s_setprio 2
    v_exp_f32 v19, v19
    v_exp_f32 v20, v20
    s_waitcnt lgkmcnt(0)
    s_mov_b64 exec, s[76:77]
    ds_read_b128 v[148:151], v159 offset:5760
    ds_read_b128 v[152:155], v159 offset:6336
    s_mov_b64 exec, -1
    ds_read_b128 v[124:127], v157 offset:6144
    ds_read_b128 v[132:135], v158 offset:36864
    v_mfma_f32_32x32x4_2b_bf16 v[48:79], v[136:137], v[122:123], 4.0
    v_exp_f32 v21, v21
    v_exp_f32 v22, v22
    v_exp_f32 v23, v23
    v_exp_f32 v24, v24
    v_exp_f32 v25, v25
    v_exp_f32 v26, v26
    v_exp_f32 v27, v27
    v_exp_f32 v28, v28
    v_smfmac_f32_32x32x32_bf16 v[80:95], v[140:143], v[16:23], v156
    v_exp_f32 v29, v29
    v_exp_f32 v30, v30
    v_exp_f32 v31, v31
    v_exp_f32 v32, v32
    v_exp_f32 v33, v33
    v_smfmac_f32_32x32x32_bf16 v[80:95], v[144:147], v[24:31], v156
    v_exp_f32 v34, v34
    v_exp_f32 v35, v35
    v_exp_f32 v36, v36
    v_exp_f32 v37, v37
    v_mfma_f32_32x32x16_bf16 v[48:63], v[128:131], v[112:115], v[48:63]
    v_exp_f32 v38, v38
    v_exp_f32 v39, v39
    v_exp_f32 v40, v40
    v_exp_f32 v41, v41
    v_smfmac_f32_32x32x32_bf16 v[96:111], v[140:143], v[32:39], v156
    v_exp_f32 v42, v42
    v_exp_f32 v43, v43
    v_exp_f32 v44, v44
    v_mfma_f32_32x32x16_bf16 v[64:79], v[128:131], v[116:119], v[64:79]
    v_exp_f32 v45, v45
    v_exp_f32 v46, v46
    v_exp_f32 v47, v47
    v_exp_f32 v48, v48
    v_readfirstlane_b32 s6, v4
    s_nop 0
    s_cmp_eq_u32 s6, 7
    s_cbranch_scc1 L_sideS
L_sideSret:
    v_exp_f32 v49, v49
    v_smfmac_f32_32x32x32_bf16 v[96:111], v[144:147], v[40:47], v156
    v_exp_f32 v50, v50
    v_exp_f32 v51, v51
    v_exp_f32 v52, v52
    s_waitcnt lgkmcnt(0)
    s_mov_b64 exec, s[76:77]
    ds_read_b128 v[140:143], v159 offset:6912
    ds_read_b128 v[144:147], v159 offset:7488
    s_mov_b64 exec, -1
    ds_read_b128 v[128:131], v157 offset:7168
    v_mfma_f32_32x32x4_2b_bf16 v[16:47], v[138:139], v[120:121], 4.0
    v_exp_f32 v53, v53
    v_exp_f32 v54, v54
    v_exp_f32 v55, v55
    v_exp_f32 v56, v56
    v_exp_f32 v57, v57
    v_exp_f32 v58, v58
    v_exp_f32 v59, v59
    v_exp_f32 v60, v60
    v_smfmac_f32_32x32x32_bf16 v[80:95], v[148:151], v[48:55], v156
    v_exp_f32 v61, v61
    v_exp_f32 v62, v62
    v_exp_f32 v63, v63
    buffer_load_dwordx4 v[248:251], v239, s[40:43], 0 offen nt
    v_exp_f32 v64, v64
    v_exp_f32 v65, v65
    v_smfmac_f32_32x32x32_bf16 v[80:95], v[152:155], v[56:63], v156
    v_exp_f32 v66, v66
    v_exp_f32 v67, v67
    v_exp_f32 v68, v68
    v_exp_f32 v69, v69
    v_mfma_f32_32x32x16_bf16 v[16:31], v[124:127], v[112:115], v[16:31]
    v_exp_f32 v70, v70
    v_exp_f32 v71, v71
    v_exp_f32 v72, v72
    v_exp_f32 v73, v73
    v_smfmac_f32_32x32x32_bf16 v[96:111], v[148:151], v[64:71], v156
    v_exp_f32 v74, v74
    v_exp_f32 v75, v75
    v_exp_f32 v76, v76
    v_mfma_f32_32x32x16_bf16 v[32:47], v[124:127], v[116:119], v[32:47]
    v_exp_f32 v77, v77
    v_exp_f32 v78, v78
    v_exp_f32 v79, v79
    v_exp_f32 v16, v16
    v_exp_f32 v17, v17
    v_smfmac_f32_32x32x32_bf16 v[96:111], v[152:155], v[72:79], v156
    v_exp_f32 v18, v18
    v_exp_f32 v19, v19
    v_exp_f32 v20, v20
    s_waitcnt lgkmcnt(0)
    s_mov_b64 exec, s[76:77]
    ds_read_b128 v[148:151], v159 offset:8064
    ds_read_b128 v[152:155], v159 offset:8640
    s_mov_b64 exec, -1
    ds_read_b128 v[124:127], v157 offset:36864
    v_mfma_f32_32x32x4_2b_bf16 v[48:79], v[138:139], v[122:123], 4.0
    v_exp_f32 v21, v21
    v_exp_f32 v22, v22
    v_exp_f32 v23, v23
    v_exp_f32 v24, v24
    v_exp_f32 v25, v25
    v_exp_f32 v26, v26
    v_exp_f32 v27, v27
    v_exp_f32 v28, v28
    v_smfmac_f32_32x32x32_bf16 v[80:95], v[140:143], v[16:23], v156
    v_exp_f32 v29, v29
    v_exp_f32 v30, v30
    v_exp_f32 v31, v31
    v_exp_f32 v32, v32
    v_exp_f32 v33, v33
    v_smfmac_f32_32x32x32_bf16 v[80:95], v[144:147], v[24:31], v156
    v_exp_f32 v34, v34
    v_exp_f32 v35, v35
    v_exp_f32 v36, v36
    v_exp_f32 v37, v37
    v_mfma_f32_32x32x16_bf16 v[48:63], v[128:131], v[112:115], v[48:63]
    v_exp_f32 v38, v38
    v_exp_f32 v39, v39
    v_exp_f32 v40, v40
    v_exp_f32 v41, v41
    v_smfmac_f32_32x32x32_bf16 v[96:111], v[140:143], v[32:39], v156
    v_exp_f32 v42, v42
    v_exp_f32 v43, v43
    ds_read_b32 v4, v5 offset:28
    v_exp_f32 v44, v44
    v_mfma_f32_32x32x16_bf16 v[64:79], v[128:131], v[116:119], v[64:79]
    v_exp_f32 v45, v45
    v_exp_f32 v46, v46
    v_exp_f32 v47, v47
    v_exp_f32 v48, v48
    v_exp_f32 v49, v49
    v_smfmac_f32_32x32x32_bf16 v[96:111], v[144:147], v[40:47], v156
    v_exp_f32 v50, v50
    v_exp_f32 v51, v51
    v_exp_f32 v52, v52
    s_waitcnt lgkmcnt(0)
    v_readfirstlane_b32 s6, v4
    s_nop 0
    s_cmp_ge_u32 s6, 8
    s_cbranch_scc0 L_cc_11s
L_cc_11:
    s_mov_b64 exec, s[76:77]
    ds_read_b128 v[140:143], v159 offset:36864
    ds_read_b128 v[144:147], v159 offset:37440
    s_mov_b64 exec, -1
    ds_read_b128 v[128:131], v157 offset:37888
    v_mfma_f32_32x32x4_2b_bf16 v[16:47], v[132:133], v[120:121], 4.0
    v_exp_f32 v53, v53
    v_exp_f32 v54, v54
    v_exp_f32 v55, v55
    v_add_u32 v157, 36864, v157
    v_add_u32 v159, 36864, v159
    v_add_u32 v158, 36864, v158
    v_exp_f32 v56, v56
    s_add_u32 s79, s79, 8192
    s_mov_b32 m0, s79
    s_nop 0
    buffer_load_dwordx4 v14, s[68:71], s79 offen sc1 lds
    v_exp_f32 v57, v57
    v_exp_f32 v58, v58
    v_exp_f32 v59, v59
    v_exp_f32 v60, v60
    v_smfmac_f32_32x32x32_bf16 v[80:95], v[148:151], v[48:55], v156
    v_exp_f32 v61, v61
    v_exp_f32 v62, v62
    v_exp_f32 v63, v63
    s_add_u32 s79, s79, 8192
    s_mov_b32 m0, s79
    s_nop 0
    buffer_load_dwordx4 v14, s[68:71], s79 offen sc1 lds
    v_exp_f32 v64, v64
    v_exp_f32 v65, v65
    v_smfmac_f32_32x32x32_bf16 v[80:95], v[152:155], v[56:63], v156
    v_exp_f32 v66, v66
    v_exp_f32 v67, v67
    v_exp_f32 v68, v68
    v_exp_f32 v69, v69
    v_mfma_f32_32x32x16_bf16 v[16:31], v[124:127], v[112:115], v[16:31]
    v_exp_f32 v70, v70
    v_exp_f32 v71, v71
    s_add_u32 s79, s79, 8192
    s_mov_b32 m0, s79
    s_nop 0
    buffer_load_dwordx4 v14, s[68:71], s79 offen sc1 lds
    v_exp_f32 v72, v72
    v_exp_f32 v73, v73
    v_smfmac_f32_32x32x32_bf16 v[96:111], v[148:151], v[64:71], v156
    v_exp_f32 v74, v74
    v_exp_f32 v75, v75
    v_exp_f32 v76, v76
    v_mfma_f32_32x32x16_bf16 v[32:47], v[124:127], v[116:119], v[32:47]
    v_exp_f32 v77, v77
    v_exp_f32 v78, v78
    v_exp_f32 v79, v79
    s_setprio 1
    v_exp_f32 v16, v16
    v_exp_f32 v17, v17
    v_smfmac_f32_32x32x32_bf16 v[96:111], v[152:155], v[72:79], v156
    v_exp_f32 v18, v18
    v_exp_f32 v19, v19
    v_exp_f32 v20, v20
    s_waitcnt lgkmcnt(0)
    s_mov_b64 exec, s[76:77]
    ds_read_b128 v[148:151], v159 offset:1152
    ds_read_b128 v[152:155], v159 offset:1728
    s_mov_b64 exec, -1
    ds_read_b128 v[124:127], v157 offset:2048
    ds_read_b128 v[136:139], v158 offset:512
    v_mfma_f32_32x32x4_2b_bf16 v[48:79], v[132:133], v[122:123], 4.0
    v_exp_f32 v21, v21
    v_exp_f32 v22, v22
    v_exp_f32 v23, v23
    v_exp_f32 v24, v24
    v_exp_f32 v25, v25
    v_exp_f32 v26, v26
    v_exp_f32 v27, v27
    v_exp_f32 v28, v28
    v_smfmac_f32_32x32x32_bf16 v[80:95], v[140:143], v[16:23], v156
    v_exp_f32 v29, v29
    v_exp_f32 v30, v30
    v_exp_f32 v31, v31
    v_exp_f32 v32, v32
    v_exp_f32 v33, v33
    v_smfmac_f32_32x32x32_bf16 v[80:95], v[144:147], v[24:31], v156
    v_exp_f32 v34, v34
    v_exp_f32 v35, v35
    v_exp_f32 v36, v36
    v_exp_f32 v37, v37
    v_mfma_f32_32x32x16_bf16 v[48:63], v[128:131], v[112:115], v[48:63]
    v_exp_f32 v38, v38
    v_exp_f32 v39, v39
    v_exp_f32 v40, v40
    v_exp_f32 v41, v41
    v_smfmac_f32_32x32x32_bf16 v[96:111], v[140:143], v[32:39], v156
    v_exp_f32 v42, v42
    v_exp_f32 v43, v43
    v_exp_f32 v44, v44
    v_mfma_f32_32x32x16_bf16 v[64:79], v[128:131], v[116:119], v[64:79]
    v_exp_f32 v45, v45
    v_exp_f32 v46, v46
    v_exp_f32 v47, v47
    v_exp_f32 v48, v48
    v_exp_f32 v49, v49
    v_smfmac_f32_32x32x32_bf16 v[96:111], v[144:147], v[40:47], v156
    v_exp_f32 v50, v50
    v_exp_f32 v51, v51
    v_exp_f32 v52, v52
    s_waitcnt lgkmcnt(0)
    s_mov_b64 exec, s[76:77]
    ds_read_b128 v[140:143], v159 offset:2304
    ds_read_b128 v[144:147], v159 offset:2880
    s_mov_b64 exec, -1
    ds_read_b128 v[128:131], v157 offset:3072
    v_mfma_f32_32x32x4_2b_bf16 v[16:47], v[134:135], v[120:121], 4.0
    v_exp_f32 v53, v53
    v_exp_f32 v54, v54
    v_exp_f32 v55, v55
    v_exp_f32 v56, v56
    v_exp_f32 v57, v57
    v_exp_f32 v58, v58
    v_exp_f32 v59, v59
    v_exp_f32 v60, v60
    v_smfmac_f32_32x32x32_bf16 v[80:95], v[148:151], v[48:55], v156
    v_exp_f32 v61, v61
    v_exp_f32 v62, v62
    v_exp_f32 v63, v63
    v_exp_f32 v64, v64
    v_exp_f32 v65, v65
    v_smfmac_f32_32x32x32_bf16 v[80:95], v[152:155], v[56:63], v156
    v_exp_f32 v66, v66
    v_exp_f32 v67, v67
    v_exp_f32 v68, v68
    v_exp_f32 v69, v69
    v_mfma_f32_32x32x16_bf16 v[16:31], v[124:127], v[112:115], v[16:31]
    v_exp_f32 v70, v70
    v_exp_f32 v71, v71
    v_exp_f32 v72, v72
    v_exp_f32 v73, v73
    v_smfmac_f32_32x32x32_bf16 v[96:111], v[148:151], v[64:71], v156
    v_exp_f32 v74, v74
    v_exp_f32 v75, v75
    v_exp_f32 v76, v76
    v_mfma_f32_32x32x16_bf16 v[32:47], v[124:127], v[116:119], v[32:47]
    v_exp_f32 v77, v77
    v_exp_f32 v78, v78
    v_exp_f32 v79, v79
    v_exp_f32 v16, v16
    v_exp_f32 v17, v17
    v_smfmac_f32_32x32x32_bf16 v[96:111], v[152:155], v[72:79], v156
    v_exp_f32 v18, v18
    v_exp_f32 v19, v19
    v_exp_f32 v20, v20
    s_waitcnt lgkmcnt(0)
    s_mov_b64 exec, s[76:77]
    ds_read_b128 v[148:151], v159 offset:3456
    ds_read_b128 v[152:155], v159 offset:4032
    s_mov_b64 exec, -1
    ds_read_b128 v[124:127], v157 offset:4096
    v_mfma_f32_32x32x4_2b_bf16 v[48:79], v[134:135], v[122:123], 4.0
    v_exp_f32 v21, v21
    v_exp_f32 v22, v22
    v_exp_f32 v23, v23
    v_exp_f32 v24, v24
    s_cmp_eq_u32 s3, 7
    s_cbranch_scc1 L_sideF
L_sideFret:
    v_exp_f32 v25, v25
    v_exp_f32 v26, v26
    v_exp_f32 v27, v27
    v_exp_f32 v28, v28
    v_smfmac_f32_32x32x32_bf16 v[80:95], v[140:143], v[16:23], v156
    v_exp_f32 v29, v29
    v_exp_f32 v30, v30
    v_exp_f32 v31, v31
    v_exp_f32 v32, v32
    v_exp_f32 v33, v33
    v_smfmac_f32_32x32x32_bf16 v[80:95], v[144:147], v[24:31], v156
    v_exp_f32 v34, v34
    v_exp_f32 v35, v35
    v_exp_f32 v36, v36
    v_exp_f32 v37, v37
    v_mfma_f32_32x32x16_bf16 v[48:63], v[128:131], v[112:115], v[48:63]
    v_exp_f32 v38, v38
    v_exp_f32 v39, v39
    v_exp_f32 v40, v40
    v_exp_f32 v41, v41
    v_smfmac_f32_32x32x32_bf16 v[96:111], v[140:143], v[32:39], v156
    v_exp_f32 v42, v42
    v_exp_f32 v43, v43
    v_exp_f32 v44, v44
    v_mfma_f32_32x32x16_bf16 v[64:79], v[128:131], v[116:119], v[64:79]
    v_exp_f32 v45, v45
    v_exp_f32 v46, v46
    v_exp_f32 v47, v47
    v_exp_f32 v48, v48
    v_exp_f32 v49, v49
    v_smfmac_f32_32x32x32_bf16 v[96:111], v[144:147], v[40:47], v156
    v_exp_f32 v50, v50
    v_exp_f32 v51, v51
    v_exp_f32 v52, v52
    s_waitcnt lgkmcnt(0)
    s_mov_b64 exec, s[76:77]
    ds_read_b128 v[140:143], v159 offset:4608
    ds_read_b128 v[144:147], v159 offset:5184
    s_mov_b64 exec, -1
    ds_read_b128 v[128:131], v157 offset:5120
    v_mfma_f32_32x32x4_2b_bf16 v[16:47], v[136:137], v[120:121], 4.0
    v_exp_f32 v53, v53
    s_setprio 0
    v_exp_f32 v54, v54
    v_exp_f32 v55, v55
    v_exp_f32 v56, v56
    v_exp_f32 v57, v57
    v_exp_f32 v58, v58
    v_exp_f32 v59, v59
    v_exp_f32 v60, v60
    v_smfmac_f32_32x32x32_bf16 v[80:95], v[148:151], v[48:55], v156
    v_exp_f32 v61, v61
    v_exp_f32 v62, v62
    v_exp_f32 v63, v63
    v_exp_f32 v64, v64
    v_exp_f32 v65, v65
    v_smfmac_f32_32x32x32_bf16 v[80:95], v[152:155], v[56:63], v156
    v_exp_f32 v66, v66
    v_exp_f32 v67, v67
    v_exp_f32 v68, v68
    v_exp_f32 v69, v69
    v_mfma_f32_32x32x16_bf16 v[16:31], v[124:127], v[112:115], v[16:31]
    v_exp_f32 v70, v70
    v_exp_f32 v71, v71
    v_exp_f32 v72, v72
    v_exp_f32 v73, v73
    v_smfmac_f32_32x32x32_bf16 v[96:111], v[148:151], v[64:71], v156
    v_exp_f32 v74, v74
    v_exp_f32 v75, v75
    v_exp_f32 v76, v76
    v_mfma_f32_32x32x16_bf16 v[32:47], v[124:127], v[116:119], v[32:47]
    v_exp_f32 v77, v77
    v_exp_f32 v78, v78
    v_exp_f32 v79, v79
    s_setprio 3
    s_waitcnt vmcnt(0)
    s_cmp_eq_u32 s3, 7
    s_cbranch_scc1 L_sideG
L_sideGret:
    s_barrier
    s_branch L_sideZ
L_sideZret:
    v_exp_f32 v16, v16
    v_exp_f32 v17, v17
    v_smfmac_f32_32x32x32_bf16 v[96:111], v[152:155], v[72:79], v156
    v_exp_f32 v18, v18
    v_exp_f32 v19, v19
    v_exp_f32 v20, v20
    s_waitcnt lgkmcnt(0)
    s_mov_b64 exec, s[76:77]
    ds_read_b128 v[148:151], v159 offset:5760
    ds_read_b128 v[152:155], v159 offset:6336
    s_mov_b64 exec, -1
    ds_read_b128 v[124:127], v157 offset:6144
    ds_read_b128 v[132:135], v158 offset:36864
    v_mfma_f32_32x32x4_2b_bf16 v[48:79], v[136:137], v[122:123], 4.0
    v_exp_f32 v21, v21
    v_exp_f32 v22, v22
    v_exp_f32 v23, v23
    v_exp_f32 v24, v24
    s_add_u32 m0, s19, 0
    s_nop 0
    buffer_load_dwordx4 v14, s[72:75], s16 offen sc1 lds
    v_exp_f32 v25, v25
    v_exp_f32 v26, v26
    v_exp_f32 v27, v27
    v_exp_f32 v28, v28
    v_smfmac_f32_32x32x32_bf16 v[80:95], v[140:143], v[16:23], v156
    v_exp_f32 v29, v29
    v_exp_f32 v30, v30
    v_exp_f32 v31, v31
    v_exp_f32 v32, v32
    v_exp_f32 v33, v33
    v_smfmac_f32_32x32x32_bf16 v[80:95], v[144:147], v[24:31], v156
    v_exp_f32 v34, v34
    v_exp_f32 v35, v35
    v_exp_f32 v36, v36
    v_exp_f32 v37, v37
    v_mfma_f32_32x32x16_bf16 v[48:63], v[128:131], v[112:115], v[48:63]
    v_exp_f32 v38, v38
    v_exp_f32 v39, v39
    s_add_u32 m0, s19, 9344
    s_nop 0
    buffer_load_dwordx4 v14, s[72:75], s17 offen sc1 lds
    v_exp_f32 v40, v40
    v_exp_f32 v41, v41
    v_smfmac_f32_32x32x32_bf16 v[96:111], v[140:143], v[32:39], v156
    v_exp_f32 v42, v42
    v_exp_f32 v43, v43
    v_exp_f32 v44, v44
    v_mfma_f32_32x32x16_bf16 v[64:79], v[128:131], v[116:119], v[64:79]
    v_exp_f32 v45, v45
    v_exp_f32 v46, v46
    v_exp_f32 v47, v47
    v_exp_f32 v48, v48
    v_exp_f32 v49, v49
    v_smfmac_f32_32x32x32_bf16 v[96:111], v[144:147], v[40:47], v156
    v_exp_f32 v50, v50
    v_exp_f32 v51, v51
    v_exp_f32 v52, v52
    s_waitcnt lgkmcnt(0)
    s_mov_b64 exec, s[76:77]
    ds_read_b128 v[140:143], v159 offset:6912
    ds_read_b128 v[144:147], v159 offset:7488
    s_mov_b64 exec, -1
    ds_read_b128 v[128:131], v157 offset:7168
    v_mfma_f32_32x32x4_2b_bf16 v[16:47], v[138:139], v[120:121], 4.0
    v_exp_f32 v53, v53
    v_exp_f32 v54, v54
    v_exp_f32 v55, v55
    v_exp_f32 v56, v56
    s_add_u32 m0, s19, 18688
    s_nop 0
    buffer_load_dwordx4 v14, s[72:75], s18 offen sc1 lds
    v_exp_f32 v57, v57
    v_exp_f32 v58, v58
    v_exp_f32 v59, v59
    v_exp_f32 v60, v60
    v_smfmac_f32_32x32x32_bf16 v[80:95], v[148:151], v[48:55], v156
    v_exp_f32 v61, v61
    v_exp_f32 v62, v62
    v_exp_f32 v63, v63
    v_exp_f32 v64, v64
    v_exp_f32 v65, v65
    v_smfmac_f32_32x32x32_bf16 v[80:95], v[152:155], v[56:63], v156
    v_exp_f32 v66, v66
    v_exp_f32 v67, v67
    v_exp_f32 v68, v68
    v_exp_f32 v69, v69
    v_mfma_f32_32x32x16_bf16 v[16:31], v[124:127], v[112:115], v[16:31]
    v_exp_f32 v70, v70
    v_exp_f32 v71, v71
    buffer_load_dwordx4 v[160:163], v14, s[68:71], s20 offen offset:0 sc1
    v_exp_f32 v72, v72
    v_exp_f32 v73, v73
    v_smfmac_f32_32x32x32_bf16 v[96:111], v[148:151], v[64:71], v156
    v_exp_f32 v74, v74
    v_exp_f32 v75, v75
    v_exp_f32 v76, v76
    v_mfma_f32_32x32x16_bf16 v[32:47], v[124:127], v[116:119], v[32:47]
    v_exp_f32 v77, v77
    v_exp_f32 v78, v78
    v_exp_f32 v79, v79
    v_exp_f32 v16, v16
    v_exp_f32 v17, v17
    v_smfmac_f32_32x32x32_bf16 v[96:111], v[152:155], v[72:79], v156
    v_exp_f32 v18, v18
    v_exp_f32 v19, v19
    v_exp_f32 v20, v20
    s_waitcnt lgkmcnt(0)
    s_mov_b64 exec, s[76:77]
    ds_read_b128 v[148:151], v159 offset:8064
    ds_read_b128 v[152:155], v159 offset:8640
    s_mov_b64 exec, -1
    ds_read_b128 v[124:127], v157 offset:36864
    v_mfma_f32_32x32x4_2b_bf16 v[48:79], v[138:139], v[122:123], 4.0
    v_exp_f32 v21, v21
    v_exp_f32 v22, v22
    v_exp_f32 v23, v23
    v_exp_f32 v24, v24
    buffer_load_dwordx4 v[164:167], v14, s[68:71], s20 offen offset:1024 sc1
    v_exp_f32 v25, v25
    v_exp_f32 v26, v26
    v_exp_f32 v27, v27
    v_exp_f32 v28, v28
    v_smfmac_f32_32x32x32_bf16 v[80:95], v[140:143], v[16:23], v156
    v_exp_f32 v29, v29
    v_exp_f32 v30, v30
    v_exp_f32 v31, v31
    v_exp_f32 v32, v32
    v_exp_f32 v33, v33
    v_smfmac_f32_32x32x32_bf16 v[80:95], v[144:147], v[24:31], v156
    v_exp_f32 v34, v34
    v_exp_f32 v35, v35
    v_exp_f32 v36, v36
    v_exp_f32 v37, v37
    v_mfma_f32_32x32x16_bf16 v[48:63], v[128:131], v[112:115], v[48:63]
    v_exp_f32 v38, v38
    v_exp_f32 v39, v39
    buffer_load_dwordx4 v[168:171], v14, s[68:71], s20 offen offset:2048 sc1
    v_exp_f32 v40, v40
    v_exp_f32 v41, v41
    v_smfmac_f32_32x32x32_bf16 v[96:111], v[140:143], v[32:39], v156
    v_exp_f32 v42, v42
    v_exp_f32 v43, v43
    v_exp_f32 v44, v44
    v_mfma_f32_32x32x16_bf16 v[64:79], v[128:131], v[116:119], v[64:79]
    v_exp_f32 v45, v45
    v_exp_f32 v46, v46
    v_exp_f32 v47, v47
    v_exp_f32 v48, v48
    v_exp_f32 v49, v49
    v_smfmac_f32_32x32x32_bf16 v[96:111], v[144:147], v[40:47], v156
    v_exp_f32 v50, v50
    v_exp_f32 v51, v51
    v_exp_f32 v52, v52
    s_waitcnt lgkmcnt(0)
    s_mov_b64 exec, s[76:77]
    ds_read_b128 v[140:143], v159 offset:36864
    ds_read_b128 v[144:147], v159 offset:37440
    s_mov_b64 exec, -1
    ds_read_b128 v[128:131], v157 offset:37888
    v_mfma_f32_32x32x4_2b_bf16 v[16:47], v[132:133], v[120:121], 4.0
    v_exp_f32 v53, v53
    v_exp_f32 v54, v54
    v_exp_f32 v55, v55
    v_add_u32 v157, 36864, v157
    v_add_u32 v159, 36864, v159
    v_add_u32 v158, 36864, v158
    v_exp_f32 v56, v56
    buffer_load_dwordx4 v[172:175], v14, s[68:71], s20 offen offset:3072 sc1
    v_exp_f32 v57, v57
    v_exp_f32 v58, v58
    v_exp_f32 v59, v59
    v_exp_f32 v60, v60
    v_smfmac_f32_32x32x32_bf16 v[80:95], v[148:151], v[48:55], v156
    v_exp_f32 v61, v61
    v_exp_f32 v62, v62
    v_exp_f32 v63, v63
    v_exp_f32 v64, v64
    v_exp_f32 v65, v65
    v_smfmac_f32_32x32x32_bf16 v[80:95], v[152:155], v[56:63], v156
    v_exp_f32 v66, v66
    v_exp_f32 v67, v67
    v_exp_f32 v68, v68
    v_exp_f32 v69, v69
    v_mfma_f32_32x32x16_bf16 v[16:31], v[124:127], v[112:115], v[16:31]
    v_exp_f32 v70, v70
    v_exp_f32 v71, v71
    s_add_u32 s20, s20, 4096
    buffer_load_dwordx4 v[176:179], v14, s[68:71], s20 offen offset:0 sc1
    v_exp_f32 v72, v72
    v_exp_f32 v73, v73
    v_smfmac_f32_32x32x32_bf16 v[96:111], v[148:151], v[64:71], v156
    v_exp_f32 v74, v74
    v_exp_f32 v75, v75
    v_exp_f32 v76, v76
    v_mfma_f32_32x32x16_bf16 v[32:47], v[124:127], v[116:119], v[32:47]
    v_exp_f32 v77, v77
    v_exp_f32 v78, v78
    v_exp_f32 v79, v79
    v_exp_f32 v16, v16
    v_exp_f32 v17, v17
    v_smfmac_f32_32x32x32_bf16 v[96:111], v[152:155], v[72:79], v156
    v_exp_f32 v18, v18
    v_exp_f32 v19, v19
    v_exp_f32 v20, v20
    s_waitcnt lgkmcnt(0)
    s_mov_b64 exec, s[76:77]
    ds_read_b128 v[148:151], v159 offset:1152
    ds_read_b128 v[152:155], v159 offset:1728
    s_mov_b64 exec, -1
    ds_read_b128 v[124:127], v157 offset:2048
    ds_read_b128 v[136:139], v158 offset:512
    v_mfma_f32_32x32x4_2b_bf16 v[48:79], v[132:133], v[122:123], 4.0
    v_exp_f32 v21, v21
    v_exp_f32 v22, v22
    v_exp_f32 v23, v23
    v_exp_f32 v24, v24
    buffer_load_dwordx4 v[180:183], v14, s[68:71], s20 offen offset:1024 sc1
    v_exp_f32 v25, v25
    v_exp_f32 v26, v26
    v_exp_f32 v27, v27
    v_exp_f32 v28, v28
    v_smfmac_f32_32x32x32_bf16 v[80:95], v[140:143], v[16:23], v156
    v_exp_f32 v29, v29
    v_exp_f32 v30, v30
    v_exp_f32 v31, v31
    v_exp_f32 v32, v32
    v_exp_f32 v33, v33
    v_smfmac_f32_32x32x32_bf16 v[80:95], v[144:147], v[24:31], v156
    v_exp_f32 v34, v34
    v_exp_f32 v35, v35
    v_exp_f32 v36, v36
    v_exp_f32 v37, v37
    v_mfma_f32_32x32x16_bf16 v[48:63], v[128:131], v[112:115], v[48:63]
    v_exp_f32 v38, v38
    v_exp_f32 v39, v39
    buffer_load_dwordx4 v[184:187], v14, s[68:71], s20 offen offset:2048 sc1
    v_exp_f32 v40, v40
    v_exp_f32 v41, v41
    v_smfmac_f32_32x32x32_bf16 v[96:111], v[140:143], v[32:39], v156
    v_exp_f32 v42, v42
    v_exp_f32 v43, v43
    v_exp_f32 v44, v44
    v_mfma_f32_32x32x16_bf16 v[64:79], v[128:131], v[116:119], v[64:79]
    v_exp_f32 v45, v45
    v_exp_f32 v46, v46
    v_exp_f32 v47, v47
    s_setprio 2
    v_exp_f32 v48, v48
    v_exp_f32 v49, v49
    v_smfmac_f32_32x32x32_bf16 v[96:111], v[144:147], v[40:47], v156
    v_exp_f32 v50, v50
    v_exp_f32 v51, v51
    v_exp_f32 v52, v52
    s_waitcnt lgkmcnt(0)
    s_mov_b64 exec, s[76:77]
    ds_read_b128 v[140:143], v159 offset:2304
    ds_read_b128 v[144:147], v159 offset:2880
    s_mov_b64 exec, -1
    ds_read_b128 v[128:131], v157 offset:3072
    v_mfma_f32_32x32x4_2b_bf16 v[16:47], v[134:135], v[120:121], 4.0
    v_exp_f32 v53, v53
    v_exp_f32 v54, v54
    v_exp_f32 v55, v55
    v_exp_f32 v56, v56
    buffer_load_dwordx4 v[188:191], v14, s[68:71], s20 offen offset:3072 sc1
    v_exp_f32 v57, v57
    v_exp_f32 v58, v58
    v_exp_f32 v59, v59
    v_exp_f32 v60, v60
    v_smfmac_f32_32x32x32_bf16 v[80:95], v[148:151], v[48:55], v156
    v_exp_f32 v61, v61
    v_exp_f32 v62, v62
    v_exp_f32 v63, v63
    v_exp_f32 v64, v64
    v_exp_f32 v65, v65
    v_smfmac_f32_32x32x32_bf16 v[80:95], v[152:155], v[56:63], v156
    v_exp_f32 v66, v66
    v_exp_f32 v67, v67
    v_exp_f32 v68, v68
    v_exp_f32 v69, v69
    v_mfma_f32_32x32x16_bf16 v[16:31], v[124:127], v[112:115], v[16:31]
    v_exp_f32 v70, v70
    v_exp_f32 v71, v71
    s_add_u32 s20, s20, 4096
    buffer_load_dwordx4 v[192:195], v14, s[68:71], s20 offen offset:0 sc1
    v_exp_f32 v72, v72
    v_exp_f32 v73, v73
    v_smfmac_f32_32x32x32_bf16 v[96:111], v[148:151], v[64:71], v156
    v_exp_f32 v74, v74
    v_exp_f32 v75, v75
    v_exp_f32 v76, v76
    v_mfma_f32_32x32x16_bf16 v[32:47], v[124:127], v[116:119], v[32:47]
    v_exp_f32 v77, v77
    v_exp_f32 v78, v78
    v_exp_f32 v79, v79
    v_exp_f32 v16, v16
    v_exp_f32 v17, v17
    v_smfmac_f32_32x32x32_bf16 v[96:111], v[152:155], v[72:79], v156
    v_exp_f32 v18, v18
    v_exp_f32 v19, v19
    v_exp_f32 v20, v20
    s_waitcnt lgkmcnt(0)
    s_mov_b64 exec, s[76:77]
    ds_read_b128 v[148:151], v159 offset:3456
    ds_read_b128 v[152:155], v159 offset:4032
    s_mov_b64 exec, -1
    ds_read_b128 v[124:127], v157 offset:4096
    v_mfma_f32_32x32x4_2b_bf16 v[48:79], v[134:135], v[122:123], 4.0
    v_exp_f32 v21, v21
    v_exp_f32 v22, v22
    v_exp_f32 v23, v23
    v_exp_f32 v24, v24
    buffer_load_dwordx4 v[196:199], v14, s[68:71], s21 offen offset:0 sc1
    v_exp_f32 v25, v25
    v_exp_f32 v26, v26
    v_exp_f32 v27, v27
    v_exp_f32 v28, v28
    v_smfmac_f32_32x32x32_bf16 v[80:95], v[140:143], v[16:23], v156
    v_exp_f32 v29, v29
    v_exp_f32 v30, v30
    v_exp_f32 v31, v31
    v_exp_f32 v32, v32
    v_exp_f32 v33, v33
    v_smfmac_f32_32x32x32_bf16 v[80:95], v[144:147], v[24:31], v156
    v_exp_f32 v34, v34
    v_exp_f32 v35, v35
    v_exp_f32 v36, v36
    v_exp_f32 v37, v37
    v_mfma_f32_32x32x16_bf16 v[48:63], v[128:131], v[112:115], v[48:63]
    v_exp_f32 v38, v38
    v_exp_f32 v39, v39
    buffer_load_dwordx4 v[200:203], v14, s[68:71], s21 offen offset:1024 sc1
    v_exp_f32 v40, v40
    v_exp_f32 v41, v41
    v_smfmac_f32_32x32x32_bf16 v[96:111], v[140:143], v[32:39], v156
    v_exp_f32 v42, v42
    v_exp_f32 v43, v43
    v_exp_f32 v44, v44
    v_mfma_f32_32x32x16_bf16 v[64:79], v[128:131], v[116:119], v[64:79]
    v_exp_f32 v45, v45
    v_exp_f32 v46, v46
    v_exp_f32 v47, v47
    v_exp_f32 v48, v48
    v_exp_f32 v49, v49
    v_smfmac_f32_32x32x32_bf16 v[96:111], v[144:147], v[40:47], v156
    v_exp_f32 v50, v50
    v_exp_f32 v51, v51
    v_exp_f32 v52, v52
    s_waitcnt lgkmcnt(0)
    s_mov_b64 exec, s[76:77]
    ds_read_b128 v[140:143], v159 offset:4608
    ds_read_b128 v[144:147], v159 offset:5184
    s_mov_b64 exec, -1
    ds_read_b128 v[128:131], v157 offset:5120
    v_mfma_f32_32x32x4_2b_bf16 v[16:47], v[136:137], v[120:121], 4.0
    v_exp_f32 v53, v53
    v_exp_f32 v54, v54
    v_exp_f32 v55, v55
    v_exp_f32 v56, v56
    buffer_load_dwordx4 v[204:207], v14, s[68:71], s21 offen offset:2048 sc1
    v_exp_f32 v57, v57
    v_exp_f32 v58, v58
    v_exp_f32 v59, v59
    v_exp_f32 v60, v60
    v_smfmac_f32_32x32x32_bf16 v[80:95], v[148:151], v[48:55], v156
    v_exp_f32 v61, v61
    v_exp_f32 v62, v62
    v_exp_f32 v63, v63
    v_exp_f32 v64, v64
    v_exp_f32 v65, v65
    v_smfmac_f32_32x32x32_bf16 v[80:95], v[152:155], v[56:63], v156
    v_exp_f32 v66, v66
    v_exp_f32 v67, v67
    v_exp_f32 v68, v68
    v_exp_f32 v69, v69
    v_mfma_f32_32x32x16_bf16 v[16:31], v[124:127], v[112:115], v[16:31]
    v_exp_f32 v70, v70
    v_exp_f32 v71, v71
    buffer_load_dwordx4 v[208:211], v14, s[68:71], s21 offen offset:3072 sc1
    v_exp_f32 v72, v72
    v_exp_f32 v73, v73
    v_smfmac_f32_32x32x32_bf16 v[96:111], v[148:151], v[64:71], v156
    v_exp_f32 v74, v74
    v_exp_f32 v75, v75
    v_exp_f32 v76, v76
    v_mfma_f32_32x32x16_bf16 v[32:47], v[124:127], v[116:119], v[32:47]
    v_exp_f32 v77, v77
    v_exp_f32 v78, v78
    v_exp_f32 v79, v79
    v_exp_f32 v16, v16
    v_exp_f32 v17, v17
    v_smfmac_f32_32x32x32_bf16 v[96:111], v[152:155], v[72:79], v156
    v_exp_f32 v18, v18
    v_exp_f32 v19, v19
    v_exp_f32 v20, v20
    s_waitcnt lgkmcnt(0)
    s_mov_b64 exec, s[76:77]
    ds_read_b128 v[148:151], v159 offset:5760
    ds_read_b128 v[152:155], v159 offset:6336
    s_mov_b64 exec, -1
    ds_read_b128 v[124:127], v157 offset:6144
    v_mfma_f32_32x32x4_2b_bf16 v[48:79], v[136:137], v[122:123], 4.0
    v_exp_f32 v21, v21
    v_exp_f32 v22, v22
    v_exp_f32 v23, v23
    v_exp_f32 v24, v24
    s_add_u32 s21, s21, 4096
    buffer_load_dwordx4 v[212:215], v14, s[68:71], s21 offen offset:0 sc1
    v_exp_f32 v25, v25
    v_exp_f32 v26, v26
    v_exp_f32 v27, v27
    v_exp_f32 v28, v28
    v_smfmac_f32_32x32x32_bf16 v[80:95], v[140:143], v[16:23], v156
    v_exp_f32 v29, v29
    v_exp_f32 v30, v30
    v_exp_f32 v31, v31
    v_exp_f32 v32, v32
    v_exp_f32 v33, v33
    v_smfmac_f32_32x32x32_bf16 v[80:95], v[144:147], v[24:31], v156
    v_exp_f32 v34, v34
    v_exp_f32 v35, v35
    v_exp_f32 v36, v36
    v_exp_f32 v37, v37
    v_mfma_f32_32x32x16_bf16 v[48:63], v[128:131], v[112:115], v[48:63]
    v_exp_f32 v38, v38
    v_exp_f32 v39, v39
    buffer_load_dwordx4 v[216:219], v14, s[68:71], s21 offen offset:1024 sc1
    v_exp_f32 v40, v40
    v_exp_f32 v41, v41
    v_smfmac_f32_32x32x32_bf16 v[96:111], v[140:143], v[32:39], v156
    v_exp_f32 v42, v42
    v_exp_f32 v43, v43
    v_exp_f32 v44, v44
    v_mfma_f32_32x32x16_bf16 v[64:79], v[128:131], v[116:119], v[64:79]
    v_exp_f32 v45, v45
    v_exp_f32 v46, v46
    v_exp_f32 v47, v47
    s_setprio 1
    v_exp_f32 v48, v48
    v_exp_f32 v49, v49
    v_smfmac_f32_32x32x32_bf16 v[96:111], v[144:147], v[40:47], v156
    v_exp_f32 v50, v50
    v_exp_f32 v51, v51
    v_exp_f32 v52, v52
    s_waitcnt lgkmcnt(0)
    s_mov_b64 exec, s[76:77]
    ds_read_b128 v[140:143], v159 offset:6912
    ds_read_b128 v[144:147], v159 offset:7488
    s_mov_b64 exec, -1
    ds_read_b128 v[128:131], v157 offset:7168
    v_mfma_f32_32x32x4_2b_bf16 v[16:47], v[138:139], v[120:121], 4.0
    v_exp_f32 v53, v53
    v_exp_f32 v54, v54
    v_exp_f32 v55, v55
    v_exp_f32 v56, v56
    buffer_load_dwordx4 v[220:223], v14, s[68:71], s21 offen offset:2048 sc1
    v_exp_f32 v57, v57
    v_exp_f32 v58, v58
    v_exp_f32 v59, v59
    v_exp_f32 v60, v60
    v_smfmac_f32_32x32x32_bf16 v[80:95], v[148:151], v[48:55], v156
    v_exp_f32 v61, v61
    v_exp_f32 v62, v62
    v_exp_f32 v63, v63
    v_exp_f32 v64, v64
    v_exp_f32 v65, v65
    v_smfmac_f32_32x32x32_bf16 v[80:95], v[152:155], v[56:63], v156
    v_exp_f32 v66, v66
    v_exp_f32 v67, v67
    v_exp_f32 v68, v68
    v_exp_f32 v69, v69
    v_mfma_f32_32x32x16_bf16 v[16:31], v[124:127], v[112:115], v[16:31]
    v_exp_f32 v70, v70
    v_exp_f32 v71, v71
    buffer_load_dwordx4 v[224:227], v14, s[68:71], s21 offen offset:3072 sc1
    v_exp_f32 v72, v72
    v_exp_f32 v73, v73
    v_smfmac_f32_32x32x32_bf16 v[96:111], v[148:151], v[64:71], v156
    v_exp_f32 v74, v74
    v_exp_f32 v75, v75
    v_exp_f32 v76, v76
    v_mfma_f32_32x32x16_bf16 v[32:47], v[124:127], v[116:119], v[32:47]
    v_exp_f32 v77, v77
    v_exp_f32 v78, v78
    v_exp_f32 v79, v79
    v_exp_f32 v16, v16
    v_exp_f32 v17, v17
    v_smfmac_f32_32x32x32_bf16 v[96:111], v[152:155], v[72:79], v156
    v_exp_f32 v18, v18
    v_exp_f32 v19, v19
    v_exp_f32 v20, v20
    s_waitcnt lgkmcnt(0)
    s_mov_b64 exec, s[76:77]
    ds_read_b128 v[148:151], v159 offset:8064
    ds_read_b128 v[152:155], v159 offset:8640
    s_mov_b64 exec, -1
    v_mfma_f32_32x32x4_2b_bf16 v[48:79], v[138:139], v[122:123], 4.0
    v_exp_f32 v21, v21
    v_exp_f32 v22, v22
    v_exp_f32 v23, v23
    v_exp_f32 v24, v24
    s_add_u32 s21, s21, 4096
    buffer_load_dwordx4 v[228:231], v14, s[68:71], s21 offen offset:0 sc1
    v_exp_f32 v25, v25
    v_exp_f32 v26, v26
    v_exp_f32 v27, v27
    v_exp_f32 v28, v28
    v_smfmac_f32_32x32x32_bf16 v[80:95], v[140:143], v[16:23], v156
    v_exp_f32 v29, v29
    v_exp_f32 v30, v30
    v_exp_f32 v31, v31
    v_exp_f32 v32, v32
    v_exp_f32 v33, v33
    v_smfmac_f32_32x32x32_bf16 v[80:95], v[144:147], v[24:31], v156
    v_exp_f32 v34, v34
    v_exp_f32 v35, v35
    v_exp_f32 v36, v36
    v_exp_f32 v37, v37
    v_mfma_f32_32x32x16_bf16 v[48:63], v[128:131], v[112:115], v[48:63]
    v_exp_f32 v38, v38
    v_exp_f32 v39, v39
    v_exp_f32 v40, v40
    v_exp_f32 v41, v41
    v_smfmac_f32_32x32x32_bf16 v[96:111], v[140:143], v[32:39], v156
    v_exp_f32 v42, v42
    v_exp_f32 v43, v43
    v_exp_f32 v44, v44
    v_mfma_f32_32x32x16_bf16 v[64:79], v[128:131], v[116:119], v[64:79]
    v_exp_f32 v45, v45
    v_exp_f32 v46, v46
    v_exp_f32 v47, v47
    v_exp_f32 v48, v48
    v_exp_f32 v49, v49
    v_smfmac_f32_32x32x32_bf16 v[96:111], v[144:147], v[40:47], v156
    v_exp_f32 v50, v50
    v_exp_f32 v51, v51
    v_exp_f32 v52, v52
    s_waitcnt lgkmcnt(0)
    v_exp_f32 v53, v53
    s_setprio 0
    v_exp_f32 v54, v54
    v_exp_f32 v55, v55
    v_exp_f32 v56, v56
    v_exp_f32 v57, v57
    v_exp_f32 v58, v58
    v_exp_f32 v59, v59
    v_exp_f32 v60, v60
    v_smfmac_f32_32x32x32_bf16 v[80:95], v[148:151], v[48:55], v156
    v_exp_f32 v61, v61
    v_exp_f32 v62, v62
    v_exp_f32 v63, v63
    v_exp_f32 v64, v64
    v_exp_f32 v65, v65
    v_smfmac_f32_32x32x32_bf16 v[80:95], v[152:155], v[56:63], v156
    v_exp_f32 v66, v66
    v_exp_f32 v67, v67
    v_exp_f32 v68, v68
    v_exp_f32 v69, v69
    v_exp_f32 v70, v70
    v_exp_f32 v71, v71
    v_exp_f32 v72, v72
    v_exp_f32 v73, v73
    v_smfmac_f32_32x32x32_bf16 v[96:111], v[148:151], v[64:71], v156
    v_exp_f32 v74, v74
    v_exp_f32 v75, v75
    v_exp_f32 v76, v76
    v_exp_f32 v77, v77
    v_exp_f32 v78, v78
    v_exp_f32 v79, v79
    s_nop 1
    v_smfmac_f32_32x32x32_bf16 v[96:111], v[152:155], v[72:79], v156
L_attdone:
    s_setprio 3
    s_lshl_b32 s6, s3, 8
    s_add_u32 s47, s6, 144384
    s_mov_b32 s49, 0
    s_lshl_b32 s52, s5, 10
    s_mov_b32 s8, 0x71800000
    s_mov_b32 s9, 0x7f800000
    s_nop 4
    ds_write_b128 v236, v[104:107] offset:2048
    ds_write_b128 v236, v[96:99]
    ds_write_b128 v236, v[100:103] offset:1024
    s_waitcnt vmcnt(18)
    s_cmp_eq_u32 s3, 0
    s_cbranch_scc0 L_noh0
    v_mul_u32_u24 v3, 9344, v1
    s_mov_b64 exec, 7
    ds_write_b16 v3, v252 offset:128
    s_mov_b64 exec, -1
L_noh0:
    s_waitcnt lgkmcnt(0)
    s_barrier
    ds_read_b128 v[104:107], v237 offset:2048
    ds_read_b128 v[96:99], v237
    ds_read_b128 v[100:103], v237 offset:1024
    ds_read_b64_tr_b16 v[16:17], v232 offset:32
    ds_read_b64_tr_b16 v[18:19], v232 offset:0
    ds_read_b64_tr_b16 v[48:49], v233 offset:0
    ds_read_b64_tr_b16 v[50:51], v233 offset:32
    ds_read_b64_tr_b16 v[20:21], v232 offset:288
    ds_read_b64_tr_b16 v[22:23], v232 offset:256
    ds_read_b64_tr_b16 v[52:53], v233 offset:256
    ds_read_b64_tr_b16 v[54:55], v233 offset:288
    ds_read_b64_tr_b16 v[24:25], v232 offset:544
    ds_read_b64_tr_b16 v[26:27], v232 offset:512
    ds_read_b64_tr_b16 v[56:57], v233 offset:512
    ds_read_b64_tr_b16 v[58:59], v233 offset:544
    s_waitcnt lgkmcnt(12)
    v_add_f32 v108, v90, v106
    v_add_f32 v109, v90, v106
    v_add_f32 v80, v80, v96
    v_add_f32 v81, v81, v97
    v_add_f32 v82, v82, v98
    v_add_f32 v83, v83, v99
    v_add_f32 v84, v84, v100
    v_add_f32 v85, v85, v101
    v_add_f32 v86, v86, v102
    v_add_f32 v87, v87, v103
    v_add_f32 v88, v88, v104
    v_add_f32 v89, v89, v105
    ds_read_b64_tr_b16 v[28:29], v232 offset:800
    ds_read_b64_tr_b16 v[30:31], v232 offset:768
    ds_read_b64_tr_b16 v[60:61], v233 offset:768
    ds_read_b64_tr_b16 v[62:63], v233 offset:800
    s_waitcnt lgkmcnt(8)
    v_mfma_f32_16x16x32_bf16 v[112:115], v[16:19], v[52:55], 0
    v_permlane32_swap_b32 v108, v109
    v_rcp_f32 v110, v108
    v_maximum3_f32 v111, |v80|, |v81|, |v82|
    v_maximum3_f32 v109, |v83|, |v84|, |v85|
    v_mfma_f32_16x16x32_bf16 v[112:115], v[20:23], v[48:51], v[112:115]
    v_mul_f32 v96, v80, v110
    v_mul_f32 v97, v81, v110
    v_mul_f32 v98, v82, v110
    v_mul_f32 v99, v83, v110
    ds_read_b64_tr_b16 v[32:33], v232 offset:1056
    ds_read_b64_tr_b16 v[34:35], v232 offset:1024
    ds_read_b64_tr_b16 v[64:65], v233 offset:1024
    ds_read_b64_tr_b16 v[66:67], v233 offset:1056
    s_waitcnt lgkmcnt(8)
    v_mfma_f32_16x16x32_bf16 v[116:119], v[20:23], v[56:59], 0
    v_mul_f32 v100, v84, v110
    v_mul_f32 v101, v85, v110
    v_mul_f32 v102, v86, v110
    v_mul_f32 v103, v87, v110
    v_mfma_f32_16x16x32_bf16 v[116:119], v[24:27], v[52:55], v[116:119]
    v_mul_f32 v104, v88, v110
    v_mul_f32 v105, v89, v110
    v_maximum3_f32 v111, v111, |v86|, |v87|
    v_maximum3_f32 v109, v109, |v88|, |v89|
    ds_read_b64_tr_b16 v[36:37], v232 offset:1312
    ds_read_b64_tr_b16 v[38:39], v232 offset:1280
    ds_read_b64_tr_b16 v[68:69], v233 offset:1280
    ds_read_b64_tr_b16 v[70:71], v233 offset:1312
    s_waitcnt lgkmcnt(8)
    v_mfma_f32_16x16x32_bf16 v[116:119], v[16:19], v[60:63], v[116:119]
    v_cmp_le_f32 vcc, 1.0, v108
    v_cmp_ge_f32 s[6:7], s8, v108
    v_cmp_gt_f32 s[10:11], s9, v111
    v_cmp_gt_f32 s[12:13], s9, v109
    v_mfma_f32_16x16x32_bf16 v[120:123], v[24:27], v[60:63], 0
    v_cvt_pk_bf16_f32 v148, v96, v97
    v_cvt_pk_bf16_f32 v149, v98, v99
    v_cvt_pk_bf16_f32 v150, v100, v101
    v_cvt_pk_bf16_f32 v151, v102, v103
    v_mfma_f32_16x16x32_bf16 v[116:119], v[28:31], v[48:51], v[116:119]
    v_cvt_pk_bf16_f32 v152, v104, v105
    s_and_b64 s[6:7], s[6:7], vcc
    s_and_b64 s[10:11], s[10:11], s[12:13]
    s_and_b64 s[6:7], s[6:7], s[10:11]
    s_cmp_eq_u64 s[6:7], -1
    s_cselect_b32 s6, 1, 0x101
    s_cmp_lg_u32 s80, 0
    s_cselect_b32 s6, 1, s6
    v_min_u32 v148, -2, v148
    v_min_u32 v149, -2, v149
    v_mfma_f32_16x16x32_bf16 v[120:123], v[28:31], v[56:59], v[120:123]
    v_min_u32 v150, -2, v150
    v_min_u32 v151, -2, v151
    v_min_u32 v152, -2, v152
    s_cmp_eq_u32 s6, 1
    s_cbranch_scc0 L_unsafe
    buffer_store_dwordx4 v[148:151], v253, s[68:71], s24 offen sc1
    s_mov_b32 exec_hi, 0
    buffer_store_dword v152, v254, s[68:71], s25 offen sc1
    s_mov_b64 exec, -1
L_unsafe:
    ds_read_b64_tr_b16 v[40:41], v232 offset:1568
    ds_read_b64_tr_b16 v[42:43], v232 offset:1536
    ds_read_b64_tr_b16 v[72:73], v233 offset:1536
    ds_read_b64_tr_b16 v[74:75], v233 offset:1568
    ds_read_b64_tr_b16 v[44:45], v232 offset:1824
    ds_read_b64_tr_b16 v[46:47], v232 offset:1792
    ds_read_b64_tr_b16 v[76:77], v233 offset:1792
    ds_read_b64_tr_b16 v[78:79], v233 offset:1824
    s_waitcnt lgkmcnt(8)
    v_mfma_f32_16x16x32_bf16 v[120:123], v[20:23], v[64:67], v[120:123]
    v_mov_b32 v9, s6
    ds_add_u32 v5, v9 offset:40
    v_mfma_f32_16x16x32_bf16 v[124:127], v[28:31], v[64:67], 0
    v_sub_u32 v2, v237, v14
    v_lshl_add_u32 v153, v1, 1, v2
    v_mfma_f32_16x16x32_bf16 v[120:123], v[32:35], v[52:55], v[120:123]
    v_add_u32 v2, 1024, v2
    v_lshl_add_u32 v155, v1, 3, v2
    v_mfma_f32_16x16x32_bf16 v[124:127], v[32:35], v[60:63], v[124:127]
    v_cmp_eq_u32 vcc, 63, v1
    v_add_u32 v154, 0x40000, v155
    ds_read_b64_tr_b16 v[80:81], v234 offset:32
    ds_read_b64_tr_b16 v[82:83], v234 offset:0
    ds_read_b64_tr_b16 v[84:85], v235 offset:3840
    ds_read_b64_tr_b16 v[86:87], v235 offset:3872
    ds_read_b64_tr_b16 v[88:89], v234 offset:288
    ds_read_b64_tr_b16 v[90:91], v234 offset:256
    ds_read_b64_tr_b16 v[92:93], v235 offset:3584
    ds_read_b64_tr_b16 v[94:95], v235 offset:3616
    ds_read_b64_tr_b16 v[96:97], v234 offset:544
    ds_read_b64_tr_b16 v[98:99], v234 offset:512
    ds_read_b64_tr_b16 v[100:101], v235 offset:3328
    ds_read_b64_tr_b16 v[102:103], v235 offset:3360
    ds_read_b64_tr_b16 v[104:105], v234 offset:800
    ds_read_b64_tr_b16 v[106:107], v234 offset:768
    ds_read_b64_tr_b16 v[108:109], v235 offset:3072
    ds_read_b64_tr_b16 v[110:111], v235 offset:3104
    s_setprio 2
    v_mfma_f32_16x16x32_bf16 v[120:123], v[16:19], v[68:71], v[120:123]
    v_mov_b32 v158, 0xfffefffe
    v_cndmask_b32 v154, v154, v2, vcc
    v_mfma_f32_16x16x32_bf16 v[124:127], v[24:27], v[68:71], v[124:127]
    v_add_f32_dpp v114, v115, v114 wave_shr:1 row_mask:0xf bank_mask:0xf bound_ctrl:0
    v_add_f32_dpp v118, v119, v118 wave_shr:1 row_mask:0xf bank_mask:0xf bound_ctrl:0
    v_mfma_f32_16x16x32_bf16 v[128:131], v[32:35], v[68:71], 0
    v_add_f32_dpp v113, v114, v113 wave_shr:1 row_mask:0xf bank_mask:0xf bound_ctrl:0
    v_add_f32_dpp v117, v118, v117 wave_shr:1 row_mask:0xf bank_mask:0xf bound_ctrl:0
    v_mfma_f32_16x16x32_bf16 v[120:123], v[36:39], v[48:51], v[120:123]
    v_add_f32_dpp v112, v113, v112 wave_shr:1 row_mask:0xf bank_mask:0xf bound_ctrl:0
    v_add_f32_dpp v116, v117, v116 wave_shr:1 row_mask:0xf bank_mask:0xf bound_ctrl:0
    v_mfma_f32_16x16x32_bf16 v[124:127], v[36:39], v[56:59], v[124:127]
    v_cvt_pk_bf16_f32 v112, v112, v116
    ds_write_b16 v153, v112 offset:0
    s_waitcnt lgkmcnt(0)
    v_mfma_f32_16x16x32_bf16 v[144:147], v[80:83], v[84:87], 0
    v_mfma_f32_16x16x32_bf16 v[144:147], v[88:91], v[92:95], v[144:147]
    v_mfma_f32_16x16x32_bf16 v[144:147], v[96:99], v[100:103], v[144:147]
    v_mfma_f32_16x16x32_bf16 v[144:147], v[104:107], v[108:111], v[144:147]
    s_cmp_ge_u32 s30, 2
    s_cbranch_scc0 L_xs0
    ds_read_b64_tr_b16 v[80:81], v234 offset:1056
    ds_read_b64_tr_b16 v[82:83], v234 offset:1024
    ds_read_b64_tr_b16 v[84:85], v235 offset:2816
    ds_read_b64_tr_b16 v[86:87], v235 offset:2848
    ds_read_b64_tr_b16 v[88:89], v234 offset:1312
    ds_read_b64_tr_b16 v[90:91], v234 offset:1280
    ds_read_b64_tr_b16 v[92:93], v235 offset:2560
    ds_read_b64_tr_b16 v[94:95], v235 offset:2592
    ds_read_b64_tr_b16 v[96:97], v234 offset:1568
    ds_read_b64_tr_b16 v[98:99], v234 offset:1536
    ds_read_b64_tr_b16 v[100:101], v235 offset:2304
    ds_read_b64_tr_b16 v[102:103], v235 offset:2336
    ds_read_b64_tr_b16 v[104:105], v234 offset:1824
    ds_read_b64_tr_b16 v[106:107], v234 offset:1792
    ds_read_b64_tr_b16 v[108:109], v235 offset:2048
    ds_read_b64_tr_b16 v[110:111], v235 offset:2080
L_xs0:
    v_mfma_f32_16x16x32_bf16 v[128:131], v[36:39], v[64:67], v[128:131]
    ds_write_b16_d16_hi v153, v112 offset:128
    v_cvt_pk_bf16_f32 v114, v113, v114
    v_mfma_f32_16x16x32_bf16 v[124:127], v[20:23], v[72:75], v[124:127]
    v_cvt_pk_bf16_f32 v115, v115, 0
    ds_write_b64 v154, v[114:115] offset:0
    v_mfma_f32_16x16x32_bf16 v[128:131], v[28:31], v[72:75], v[128:131]
    v_cvt_pk_bf16_f32 v118, v117, v118
    v_cvt_pk_bf16_f32 v119, v119, 0
    v_mfma_f32_16x16x32_bf16 v[132:135], v[36:39], v[72:75], 0
    ds_write_b64 v154, v[118:119] offset:8
    v_lshrrev_b32 v2, 3, v1
    v_mfma_f32_16x16x32_bf16 v[124:127], v[40:43], v[52:55], v[124:127]
    v_and_b32 v3, 7, v1
    v_lshlrev_b32 v3, 4, v3
    s_cmp_ge_u32 s30, 2
    s_cbranch_scc0 L_xs1
    s_waitcnt lgkmcnt(0)
    v_mfma_f32_16x16x32_bf16 v[144:147], v[80:83], v[84:87], v[144:147]
    v_mfma_f32_16x16x32_bf16 v[144:147], v[88:91], v[92:95], v[144:147]
    v_mfma_f32_16x16x32_bf16 v[144:147], v[96:99], v[100:103], v[144:147]
    v_mfma_f32_16x16x32_bf16 v[144:147], v[104:107], v[108:111], v[144:147]
    s_cmp_ge_u32 s30, 4
    s_cbranch_scc0 L_xs1
    ds_read_b64_tr_b16 v[80:81], v234 offset:2080
    ds_read_b64_tr_b16 v[82:83], v234 offset:2048
    ds_read_b64_tr_b16 v[84:85], v235 offset:1792
    ds_read_b64_tr_b16 v[86:87], v235 offset:1824
    ds_read_b64_tr_b16 v[88:89], v234 offset:2336
    ds_read_b64_tr_b16 v[90:91], v234 offset:2304
    ds_read_b64_tr_b16 v[92:93], v235 offset:1536
    ds_read_b64_tr_b16 v[94:95], v235 offset:1568
    ds_read_b64_tr_b16 v[96:97], v234 offset:2592
    ds_read_b64_tr_b16 v[98:99], v234 offset:2560
    ds_read_b64_tr_b16 v[100:101], v235 offset:1280
    ds_read_b64_tr_b16 v[102:103], v235 offset:1312
    ds_read_b64_tr_b16 v[104:105], v234 offset:2848
    ds_read_b64_tr_b16 v[106:107], v234 offset:2816
    ds_read_b64_tr_b16 v[108:109], v235 offset:1024
    ds_read_b64_tr_b16 v[110:111], v235 offset:1056
L_xs1:
    v_mfma_f32_16x16x32_bf16 v[128:131], v[40:43], v[60:63], v[128:131]
    v_lshl_add_u32 v156, v2, 9, v3
    v_mul_u32_u24 v157, 18432, v1
    v_mfma_f32_16x16x32_bf16 v[132:135], v[40:43], v[68:71], v[132:135]
    v_add_u32 v157, s27, v157
    v_writelane_b32 v157, s29, 8
    v_mfma_f32_16x16x32_bf16 v[124:127], v[16:19], v[76:79], v[124:127]
    v_lshlrev_b32 v8, 1, v1
    v_mfma_f32_16x16x32_bf16 v[128:131], v[24:27], v[76:79], v[128:131]
    v_mfma_f32_16x16x32_bf16 v[132:135], v[32:35], v[76:79], v[132:135]
    s_cmp_ge_u32 s30, 4
    s_cbranch_scc0 L_xs2
    s_waitcnt lgkmcnt(0)
    v_mfma_f32_16x16x32_bf16 v[144:147], v[80:83], v[84:87], v[144:147]
    v_mfma_f32_16x16x32_bf16 v[144:147], v[88:91], v[92:95], v[144:147]
    v_mfma_f32_16x16x32_bf16 v[144:147], v[96:99], v[100:103], v[144:147]
    v_mfma_f32_16x16x32_bf16 v[144:147], v[104:107], v[108:111], v[144:147]
    s_cmp_ge_u32 s30, 6
    s_cbranch_scc0 L_xs2
    ds_read_b64_tr_b16 v[80:81], v234 offset:3104
    ds_read_b64_tr_b16 v[82:83], v234 offset:3072
    ds_read_b64_tr_b16 v[84:85], v235 offset:768
    ds_read_b64_tr_b16 v[86:87], v235 offset:800
    ds_read_b64_tr_b16 v[88:89], v234 offset:3360
    ds_read_b64_tr_b16 v[90:91], v234 offset:3328
    ds_read_b64_tr_b16 v[92:93], v235 offset:512
    ds_read_b64_tr_b16 v[94:95], v235 offset:544
    ds_read_b64_tr_b16 v[96:97], v234 offset:3616
    ds_read_b64_tr_b16 v[98:99], v234 offset:3584
    ds_read_b64_tr_b16 v[100:101], v235 offset:256
    ds_read_b64_tr_b16 v[102:103], v235 offset:288
    ds_read_b64_tr_b16 v[104:105], v234 offset:3872
    ds_read_b64_tr_b16 v[106:107], v234 offset:3840
    ds_read_b64_tr_b16 v[108:109], v235 offset:0
    ds_read_b64_tr_b16 v[110:111], v235 offset:32
L_xs2:
    v_mfma_f32_16x16x32_bf16 v[136:139], v[40:43], v[76:79], 0
    s_add_u32 m0, s39, s52
    s_add_u32 s8, s100, s52
    buffer_load_dwordx4 v14, s[68:71], s8 offen sc1 lds
    s_add_u32 s52, s52, 1024
    s_cmp_eq_u32 s52, 9216
    s_cselect_b32 s52, 0, s52
    v_mfma_f32_16x16x32_bf16 v[124:127], v[44:47], v[48:51], v[124:127]
    v_mfma_f32_16x16x32_bf16 v[128:131], v[44:47], v[56:59], v[128:131]
    v_mfma_f32_16x16x32_bf16 v[132:135], v[44:47], v[64:67], v[132:135]
    v_mfma_f32_16x16x32_bf16 v[136:139], v[44:47], v[72:75], v[136:139]
    s_cmp_ge_u32 s30, 6
    s_cbranch_scc0 L_xs3
    s_waitcnt lgkmcnt(0)
    v_mfma_f32_16x16x32_bf16 v[144:147], v[80:83], v[84:87], v[144:147]
    v_mfma_f32_16x16x32_bf16 v[144:147], v[88:91], v[92:95], v[144:147]
    v_mfma_f32_16x16x32_bf16 v[144:147], v[96:99], v[100:103], v[144:147]
    v_mfma_f32_16x16x32_bf16 v[144:147], v[104:107], v[108:111], v[144:147]
L_xs3:
    ds_read_b64_tr_b16 v[80:81], v232 offset:2080
    ds_read_b64_tr_b16 v[82:83], v232 offset:2048
    ds_read_b64_tr_b16 v[84:85], v233 offset:2048
    ds_read_b64_tr_b16 v[86:87], v233 offset:2080
    ds_read_b64_tr_b16 v[88:89], v232 offset:2336
    ds_read_b64_tr_b16 v[90:91], v232 offset:2304
    ds_read_b64_tr_b16 v[92:93], v233 offset:2304
    ds_read_b64_tr_b16 v[94:95], v233 offset:2336
    ds_read_b64_tr_b16 v[96:97], v232 offset:2592
    ds_read_b64_tr_b16 v[98:99], v232 offset:2560
    ds_read_b64_tr_b16 v[100:101], v233 offset:2560
    ds_read_b64_tr_b16 v[102:103], v233 offset:2592
    s_setprio 1
    v_add_f32_dpp v122, v123, v122 wave_shr:1 row_mask:0xf bank_mask:0xf bound_ctrl:0
    v_add_f32_dpp v126, v127, v126 wave_shr:1 row_mask:0xf bank_mask:0xf bound_ctrl:0
    s_nop 0
    v_add_f32_dpp v121, v122, v121 wave_shr:1 row_mask:0xf bank_mask:0xf bound_ctrl:0
    v_add_f32_dpp v125, v126, v125 wave_shr:1 row_mask:0xf bank_mask:0xf bound_ctrl:0
    s_nop 0
    v_add_f32_dpp v120, v121, v120 wave_shr:1 row_mask:0xf bank_mask:0xf bound_ctrl:0
    v_add_f32_dpp v124, v125, v124 wave_shr:1 row_mask:0xf bank_mask:0xf bound_ctrl:0
    v_cvt_pk_bf16_f32 v120, v120, v124
    s_waitcnt lgkmcnt(8)
    ds_read_b64_tr_b16 v[104:105], v232 offset:2848
    ds_read_b64_tr_b16 v[106:107], v232 offset:2816
    ds_read_b64_tr_b16 v[108:109], v233 offset:2816
    ds_read_b64_tr_b16 v[110:111], v233 offset:2848
    v_mfma_f32_16x16x32_bf16 v[128:131], v[20:23], v[84:87], v[128:131]
    s_add_u32 m0, s39, s52
    s_add_u32 s8, s100, s52
    buffer_load_dwordx4 v14, s[68:71], s8 offen sc1 lds
    s_add_u32 s52, s52, 1024
    s_cmp_eq_u32 s52, 9216
    s_cselect_b32 s52, 0, s52
    ds_write_b16 v153, v120 offset:256
    ds_write_b16_d16_hi v153, v120 offset:384
    v_mfma_f32_16x16x32_bf16 v[132:135], v[28:31], v[84:87], v[132:135]
    v_cvt_pk_bf16_f32 v122, v121, v122
    v_cvt_pk_bf16_f32 v123, v123, 0
    v_mfma_f32_16x16x32_bf16 v[136:139], v[36:39], v[84:87], v[136:139]
    ds_write_b64 v154, v[122:123] offset:16
    v_cvt_pk_bf16_f32 v126, v125, v126
    v_mfma_f32_16x16x32_bf16 v[140:143], v[44:47], v[84:87], 0
    v_cvt_pk_bf16_f32 v127, v127, 0
    ds_write_b64 v154, v[126:127] offset:24
    v_mfma_f32_16x16x32_bf16 v[128:131], v[80:83], v[52:55], v[128:131]
    v_add_f32_dpp v146, v147, v146 wave_shr:1 row_mask:0xf bank_mask:0xf bound_ctrl:0
    v_mfma_f32_16x16x32_bf16 v[132:135], v[80:83], v[60:63], v[132:135]
    s_add_u32 m0, s39, s52
    s_add_u32 s8, s100, s52
    buffer_load_dwordx4 v14, s[68:71], s8 offen sc1 lds
    s_add_u32 s52, s52, 1024
    s_cmp_eq_u32 s52, 9216
    s_cselect_b32 s52, 0, s52
    v_add_f32_dpp v145, v146, v145 wave_shr:1 row_mask:0xf bank_mask:0xf bound_ctrl:0
    v_mfma_f32_16x16x32_bf16 v[136:139], v[80:83], v[68:71], v[136:139]
    v_mfma_f32_16x16x32_bf16 v[140:143], v[80:83], v[76:79], v[140:143]
    v_add_f32_dpp v144, v145, v144 wave_shr:1 row_mask:0xf bank_mask:0xf bound_ctrl:0
    v_cvt_pk_bf16_f32 v144, v144, v144
    s_waitcnt lgkmcnt(12)
    ds_read_b64_tr_b16 v[80:81], v232 offset:3104
    ds_read_b64_tr_b16 v[82:83], v232 offset:3072
    ds_read_b64_tr_b16 v[84:85], v233 offset:3072
    ds_read_b64_tr_b16 v[86:87], v233 offset:3104
    v_mfma_f32_16x16x32_bf16 v[128:131], v[16:19], v[92:95], v[128:131]
    v_pk_min_u16 v144, v144, v158
    buffer_store_short v144, v8, s[68:71], s28 offen sc1
    v_mfma_f32_16x16x32_bf16 v[132:135], v[24:27], v[92:95], v[132:135]
    v_cvt_pk_bf16_f32 v146, v145, v146
    v_cvt_pk_bf16_f32 v147, v147, 0
    v_mfma_f32_16x16x32_bf16 v[136:139], v[32:35], v[92:95], v[136:139]
    s_add_u32 m0, s39, s52
    s_add_u32 s8, s100, s52
    buffer_load_dwordx4 v14, s[68:71], s8 offen sc1 lds
    s_add_u32 s52, s52, 1024
    s_cmp_eq_u32 s52, 9216
    s_cselect_b32 s52, 0, s52
    ds_write_b64 v154, v[146:147] offset:64
    v_mfma_f32_16x16x32_bf16 v[140:143], v[40:43], v[92:95], v[140:143]
    v_mfma_f32_16x16x32_bf16 v[128:131], v[88:91], v[48:51], v[128:131]
    v_mfma_f32_16x16x32_bf16 v[132:135], v[88:91], v[56:59], v[132:135]
    v_mfma_f32_16x16x32_bf16 v[136:139], v[88:91], v[64:67], v[136:139]
    v_mfma_f32_16x16x32_bf16 v[140:143], v[88:91], v[72:75], v[140:143]
    s_add_u32 m0, s39, s52
    s_add_u32 s8, s100, s52
    buffer_load_dwordx4 v14, s[68:71], s8 offen sc1 lds
    s_add_u32 s52, s52, 1024
    s_cmp_eq_u32 s52, 9216
    s_cselect_b32 s52, 0, s52
    s_waitcnt lgkmcnt(13)
    ds_read_b64_tr_b16 v[88:89], v232 offset:3360
    ds_read_b64_tr_b16 v[90:91], v232 offset:3328
    ds_read_b64_tr_b16 v[92:93], v233 offset:3328
    ds_read_b64_tr_b16 v[94:95], v233 offset:3360
    v_mfma_f32_16x16x32_bf16 v[132:135], v[20:23], v[100:103], v[132:135]
    v_mfma_f32_16x16x32_bf16 v[136:139], v[28:31], v[100:103], v[136:139]
    v_mfma_f32_16x16x32_bf16 v[140:143], v[36:39], v[100:103], v[140:143]
    v_mfma_f32_16x16x32_bf16 v[132:135], v[96:99], v[52:55], v[132:135]
    v_mfma_f32_16x16x32_bf16 v[136:139], v[96:99], v[60:63], v[136:139]
    s_add_u32 m0, s39, s52
    s_add_u32 s8, s100, s52
    buffer_load_dwordx4 v14, s[68:71], s8 offen sc1 lds
    s_add_u32 s52, s52, 1024
    s_cmp_eq_u32 s52, 9216
    s_cselect_b32 s52, 0, s52
    v_mfma_f32_16x16x32_bf16 v[140:143], v[96:99], v[68:71], v[140:143]
    s_waitcnt lgkmcnt(13)
    ds_read_b64_tr_b16 v[96:97], v232 offset:3616
    ds_read_b64_tr_b16 v[98:99], v232 offset:3584
    ds_read_b64_tr_b16 v[100:101], v233 offset:3584
    ds_read_b64_tr_b16 v[102:103], v233 offset:3616
    s_setprio 0
    v_mfma_f32_16x16x32_bf16 v[132:135], v[16:19], v[108:111], v[132:135]
    v_mfma_f32_16x16x32_bf16 v[136:139], v[24:27], v[108:111], v[136:139]
    v_mfma_f32_16x16x32_bf16 v[140:143], v[32:35], v[108:111], v[140:143]
    v_mfma_f32_16x16x32_bf16 v[132:135], v[104:107], v[48:51], v[132:135]
    s_add_u32 m0, s39, s52
    s_add_u32 s8, s100, s52
    buffer_load_dwordx4 v14, s[68:71], s8 offen sc1 lds
    s_add_u32 s52, s52, 1024
    s_cmp_eq_u32 s52, 9216
    s_cselect_b32 s52, 0, s52
    v_mfma_f32_16x16x32_bf16 v[136:139], v[104:107], v[56:59], v[136:139]
    v_mfma_f32_16x16x32_bf16 v[140:143], v[104:107], v[64:67], v[140:143]
    s_waitcnt lgkmcnt(9)
    ds_read_b64_tr_b16 v[104:105], v232 offset:3872
    ds_read_b64_tr_b16 v[106:107], v232 offset:3840
    ds_read_b64_tr_b16 v[108:109], v233 offset:3840
    ds_read_b64_tr_b16 v[110:111], v233 offset:3872
    v_mfma_f32_16x16x32_bf16 v[136:139], v[20:23], v[84:87], v[136:139]
    v_mfma_f32_16x16x32_bf16 v[140:143], v[28:31], v[84:87], v[140:143]
    v_mfma_f32_16x16x32_bf16 v[136:139], v[80:83], v[52:55], v[136:139]
    s_add_u32 m0, s39, s52
    s_add_u32 s8, s100, s52
    buffer_load_dwordx4 v14, s[68:71], s8 offen sc1 lds
    s_add_u32 s52, s52, 1024
    s_cmp_eq_u32 s52, 9216
    s_cselect_b32 s52, 0, s52
    v_mfma_f32_16x16x32_bf16 v[140:143], v[80:83], v[60:63], v[140:143]
    v_add_f32_dpp v130, v131, v130 wave_shr:1 row_mask:0xf bank_mask:0xf bound_ctrl:0
    v_add_f32_dpp v134, v135, v134 wave_shr:1 row_mask:0xf bank_mask:0xf bound_ctrl:0
    s_waitcnt lgkmcnt(8)
    v_mfma_f32_16x16x32_bf16 v[136:139], v[16:19], v[92:95], v[136:139]
    v_add_f32_dpp v129, v130, v129 wave_shr:1 row_mask:0xf bank_mask:0xf bound_ctrl:0
    v_add_f32_dpp v133, v134, v133 wave_shr:1 row_mask:0xf bank_mask:0xf bound_ctrl:0
    v_mfma_f32_16x16x32_bf16 v[140:143], v[24:27], v[92:95], v[140:143]
    v_add_f32_dpp v128, v129, v128 wave_shr:1 row_mask:0xf bank_mask:0xf bound_ctrl:0
    v_add_f32_dpp v132, v133, v132 wave_shr:1 row_mask:0xf bank_mask:0xf bound_ctrl:0
    v_mfma_f32_16x16x32_bf16 v[136:139], v[88:91], v[48:51], v[136:139]
    v_cvt_pk_bf16_f32 v128, v128, v132
    ds_write_b16 v153, v128 offset:512
    v_mfma_f32_16x16x32_bf16 v[140:143], v[88:91], v[56:59], v[140:143]
    s_add_u32 m0, s39, s52
    s_add_u32 s8, s100, s52
    buffer_load_dwordx4 v14, s[68:71], s8 offen sc1 lds
    s_add_u32 s52, s52, 1024
    s_cmp_eq_u32 s52, 9216
    s_cselect_b32 s52, 0, s52
    ds_write_b16_d16_hi v153, v128 offset:640
    v_cvt_pk_bf16_f32 v130, v129, v130
    s_waitcnt lgkmcnt(6)
    v_mfma_f32_16x16x32_bf16 v[140:143], v[20:23], v[100:103], v[140:143]
    v_cvt_pk_bf16_f32 v131, v131, 0
    ds_write_b64 v154, v[130:131] offset:32
    v_mfma_f32_16x16x32_bf16 v[140:143], v[96:99], v[52:55], v[140:143]
    v_cvt_pk_bf16_f32 v134, v133, v134
    v_cvt_pk_bf16_f32 v135, v135, 0
    s_waitcnt lgkmcnt(3)
    v_mfma_f32_16x16x32_bf16 v[140:143], v[16:19], v[108:111], v[140:143]
    ds_write_b64 v154, v[134:135] offset:40
    v_mfma_f32_16x16x32_bf16 v[140:143], v[104:107], v[48:51], v[140:143]
    v_add_f32_dpp v138, v139, v138 wave_shr:1 row_mask:0xf bank_mask:0xf bound_ctrl:0
    s_nop 6
    v_add_f32_dpp v142, v143, v142 wave_shr:1 row_mask:0xf bank_mask:0xf bound_ctrl:0
    v_add_f32_dpp v137, v138, v137 wave_shr:1 row_mask:0xf bank_mask:0xf bound_ctrl:0
    s_nop 0
    v_add_f32_dpp v141, v142, v141 wave_shr:1 row_mask:0xf bank_mask:0xf bound_ctrl:0
    v_add_f32_dpp v136, v137, v136 wave_shr:1 row_mask:0xf bank_mask:0xf bound_ctrl:0
    s_nop 0
    v_add_f32_dpp v140, v141, v140 wave_shr:1 row_mask:0xf bank_mask:0xf bound_ctrl:0
    v_cvt_pk_bf16_f32 v136, v136, v140
    ds_write_b16 v153, v136 offset:768
    ds_write_b16_d16_hi v153, v136 offset:896
    v_cvt_pk_bf16_f32 v138, v137, v138
    v_cvt_pk_bf16_f32 v139, v139, 0
    ds_write_b64 v154, v[138:139] offset:48
    v_cvt_pk_bf16_f32 v142, v141, v142
    v_cvt_pk_bf16_f32 v143, v143, 0
    ds_write_b64 v154, v[142:143] offset:56
    ds_read_b128 v[16:19], v237
    ds_read_b64 v[20:21], v155
    ds_read_b32 v4, v5 offset:40
    v_add_u32 v7, s39, v14
    s_waitcnt lgkmcnt(2)
    v_pk_min_u16 v16, v16, v158
    v_pk_min_u16 v17, v17, v158
    v_pk_min_u16 v18, v18, v158
    v_pk_min_u16 v19, v19, v158
    buffer_store_dwordx4 v[16:19], v156, s[68:71], s26 offen sc1
    s_waitcnt lgkmcnt(0)
    v_pk_min_u16 v20, v20, v158
    v_pk_min_u16 v21, v21, v158
    s_mov_b64 exec, 0x1ff
    buffer_store_dwordx2 v[20:21], v157, s[68:71], 0 offen sc1
    s_mov_b64 exec, -1
    v_readfirstlane_b32 s6, v4
    s_nop 0
    s_cmp_eq_u32 s6, 8
    s_cbranch_scc0 L_fo
L_for:
    s_mov_b32 s83, 20000
    s_waitcnt vmcnt(2)
L_ochk:
    ds_read_b128 v[32:35], v7 offset:0
    ds_read_b128 v[36:39], v7 offset:1024
    ds_read_b128 v[40:43], v7 offset:2048
    ds_read_b128 v[44:47], v7 offset:3072
    ds_read_b128 v[48:51], v7 offset:4096
    ds_read_b128 v[52:55], v7 offset:5120
    ds_read_b128 v[56:59], v7 offset:6144
    ds_read_b128 v[60:63], v7 offset:7168
    ds_read_b128 v[64:67], v7 offset:8192
    v_add_u32 v140, s56, v14
    v_add_u32 v141, s57, v14
    v_add_u32 v142, s58, v14
    v_add_u32 v143, s59, v14
    s_waitcnt lgkmcnt(6)
    v_max3_u32 v24, v32, v33, 0
    v_max3_u32 v25, v34, v35, 0
    v_max3_u32 v24, v36, v37, v24
    v_max3_u32 v25, v38, v39, v25
    v_max3_u32 v24, v40, v41, v24
    v_max3_u32 v25, v42, v43, v25
    s_waitcnt lgkmcnt(3)
    v_max3_u32 v24, v44, v45, v24
    v_max3_u32 v25, v46, v47, v25
    v_max3_u32 v24, v48, v49, v24
    v_max3_u32 v25, v50, v51, v25
    v_max3_u32 v24, v52, v53, v24
    v_max3_u32 v25, v54, v55, v25
    s_waitcnt lgkmcnt(0)
    v_max3_u32 v24, v56, v57, v24
    v_max3_u32 v25, v58, v59, v25
    v_max3_u32 v24, v60, v61, v24
    v_max3_u32 v25, v62, v63, v25
    v_max3_u32 v24, v64, v65, v24
    v_max3_u32 v25, v66, v67, v25
    v_max_u32 v24, v24, v25
    v_cmp_eq_u32 vcc, -1, v24
    s_nop 0
    s_cmp_eq_u64 vcc, 0
    s_cbranch_scc0 L_oagain
L_ogot:
    s_setprio 3
    s_barrier
    ds_read_b128 v[16:19], v140 offset:0
    ds_read_b128 v[52:55], v141 offset:0
    ds_read_b128 v[20:23], v140 offset:1024
    ds_read_b128 v[56:59], v141 offset:1024
    ds_read_b128 v[24:27], v140 offset:2048
    ds_read_b128 v[60:63], v141 offset:2048
    ds_read_b128 v[28:31], v140 offset:3072
    ds_read_b128 v[64:67], v141 offset:3072
    v_lshrrev_b32 v2, 1, v1
    v_and_b32 v7, 1, v1
    v_lshlrev_b32 v7, 4, v7
    v_lshl_add_u32 v149, v2, 12, v7
    s_setprio 3
    s_waitcnt lgkmcnt(6)
    ds_read_b128 v[32:35], v140 offset:4096
    ds_read_b128 v[68:71], v141 offset:4096
    v_mfma_f32_16x16x32_bf16 v[112:115], v[160:163], v[16:19], 0
    s_mov_b32 m0, s22
    s_nop 0
    buffer_load_dwordx4 v149, s[68:71], s101 offen sc1 lds
    s_mov_b32 m0, s47
    s_mov_b64 exec, 0xffff
    buffer_load_dwordx4 v14, s[68:71], s81 offen sc1 lds
    s_mov_b64 exec, -1
    v_mfma_f32_16x16x32_bf16 v[128:131], v[196:199], v[16:19], 0
    s_cmp_eq_u32 s3, 3
    s_cbranch_scc1 L_x3
L_nox3:
    v_mfma_f32_16x16x32_bf16 v[116:119], v[160:163], v[52:55], 0
    v_and_b32 v3, 15, v1
    s_waitcnt lgkmcnt(6)
    ds_read_b128 v[36:39], v140 offset:5120
    ds_read_b128 v[72:75], v141 offset:5120
    v_mfma_f32_16x16x32_bf16 v[112:115], v[164:167], v[20:23], v[112:115]
    v_mul_u32_u24 v3, 304, v3
    v_mfma_f32_16x16x32_bf16 v[128:131], v[200:203], v[20:23], v[128:131]
    v_lshl_add_u32 v2, v10, 5, v3
    v_mfma_f32_16x16x32_bf16 v[116:119], v[164:167], v[56:59], v[116:119]
    v_add_u32 v152, s38, v2
    s_waitcnt lgkmcnt(6)
    ds_read_b128 v[40:43], v140 offset:6144
    ds_read_b128 v[76:79], v141 offset:6144
    v_mfma_f32_16x16x32_bf16 v[112:115], v[168:171], v[24:27], v[112:115]
    v_lshl_add_u32 v3, v10, 4, v3
    v_mfma_f32_16x16x32_bf16 v[128:131], v[204:207], v[24:27], v[128:131]
    v_add_u32 v148, s36, v3
    v_mfma_f32_16x16x32_bf16 v[116:119], v[168:171], v[60:63], v[116:119]
    v_add_u32 v144, s32, v3
    s_waitcnt lgkmcnt(6)
    ds_read_b128 v[44:47], v140 offset:7168
    ds_read_b128 v[80:83], v141 offset:7168
    v_mfma_f32_16x16x32_bf16 v[112:115], v[172:175], v[28:31], v[112:115]
    v_add_u32 v145, s33, v3
    v_mfma_f32_16x16x32_bf16 v[128:131], v[208:211], v[28:31], v[128:131]
    v_add_u32 v146, s34, v3
    v_mfma_f32_16x16x32_bf16 v[116:119], v[172:175], v[64:67], v[116:119]
    v_add_u32 v147, s35, v3
    s_waitcnt lgkmcnt(6)
    ds_read_b128 v[48:51], v140 offset:8192
    ds_read_b128 v[84:87], v141 offset:8192
    v_mfma_f32_16x16x32_bf16 v[112:115], v[176:179], v[32:35], v[112:115]
    v_lshl_add_u32 v2, v10, 3, v11
    v_mfma_f32_16x16x32_bf16 v[128:131], v[212:215], v[32:35], v[128:131]
    v_lshlrev_b32 v7, 5, v2
    v_mfma_f32_16x16x32_bf16 v[116:119], v[176:179], v[68:71], v[116:119]
    v_lshl_add_u32 v7, v12, 3, v7
    s_setprio 2
    s_waitcnt lgkmcnt(6)
    v_mfma_f32_16x16x32_bf16 v[112:115], v[180:183], v[36:39], v[112:115]
    v_add_u32 v150, s22, v7
    v_mfma_f32_16x16x32_bf16 v[128:131], v[216:219], v[36:39], v[128:131]
    v_cmp_eq_u32 vcc, 0, v12
    v_mfma_f32_16x16x32_bf16 v[116:119], v[180:183], v[72:75], v[116:119]
    v_lshl_add_u32 v2, v2, 3, s47
    ds_read_b128 v[16:19], v142 offset:0
    ds_read_b128 v[52:55], v143 offset:0
    s_waitcnt lgkmcnt(6)
    v_mfma_f32_16x16x32_bf16 v[112:115], v[184:187], v[40:43], v[112:115]
    v_mov_b32 v9, 162304
    v_mfma_f32_16x16x32_bf16 v[128:131], v[220:223], v[40:43], v[128:131]
    v_cndmask_b32 v151, v9, v2, vcc
    v_mfma_f32_16x16x32_bf16 v[116:119], v[184:187], v[76:79], v[116:119]
    v_lshlrev_b32 v88, 16, v244
    ds_read_b128 v[20:23], v142 offset:1024
    ds_read_b128 v[56:59], v143 offset:1024
    s_waitcnt lgkmcnt(6)
    v_mfma_f32_16x16x32_bf16 v[112:115], v[188:191], v[44:47], v[112:115]
    v_and_b32 v89, 0xffff0000, v244
    v_mfma_f32_16x16x32_bf16 v[128:131], v[224:227], v[44:47], v[128:131]
    v_lshlrev_b32 v90, 16, v245
    v_mfma_f32_16x16x32_bf16 v[116:119], v[188:191], v[80:83], v[116:119]
    v_and_b32 v91, 0xffff0000, v245
    ds_read_b128 v[24:27], v142 offset:2048
    ds_read_b128 v[60:63], v143 offset:2048
    s_waitcnt lgkmcnt(6)
    v_mfma_f32_16x16x32_bf16 v[112:115], v[192:195], v[48:51], v[112:115]
    v_lshlrev_b32 v92, 16, v246
    v_mfma_f32_16x16x32_bf16 v[128:131], v[228:231], v[48:51], v[128:131]
    v_and_b32 v93, 0xffff0000, v246
    v_mfma_f32_16x16x32_bf16 v[116:119], v[192:195], v[84:87], v[116:119]
    v_lshlrev_b32 v94, 16, v247
    ds_read_b128 v[28:31], v142 offset:3072
    ds_read_b128 v[64:67], v143 offset:3072
    s_setprio 1
    v_and_b32 v95, 0xffff0000, v247
    s_waitcnt vmcnt(0)
    ds_read_b64_tr_b16 v[132:133], v150
    ds_read_b64_tr_b16 v[134:135], v150 offset:128
    ds_read_b64_tr_b16 v[136:137], v151
    ds_read_b64_tr_b16 v[138:139], v151 offset:32
    s_waitcnt lgkmcnt(10)
    v_mfma_f32_16x16x32_bf16 v[120:123], v[160:163], v[16:19], 0
    v_mfma_f32_16x16x32_bf16 v[124:127], v[160:163], v[52:55], 0
    ds_read_b128 v[32:35], v142 offset:4096
    ds_read_b128 v[68:71], v143 offset:4096
    s_waitcnt lgkmcnt(10)
    v_mfma_f32_16x16x32_bf16 v[120:123], v[164:167], v[20:23], v[120:123]
    v_mfma_f32_16x16x32_bf16 v[124:127], v[164:167], v[56:59], v[124:127]
    ds_read_b128 v[36:39], v142 offset:5120
    ds_read_b128 v[72:75], v143 offset:5120
    s_waitcnt lgkmcnt(10)
    s_waitcnt lgkmcnt(4)
    v_mfma_f32_16x16x32_bf16 v[120:123], v[168:171], v[24:27], v[120:123]
    v_pk_max_u16 v2, v132, v133
    v_pk_max_u16 v3, v134, v135
    v_pk_max_u16 v7, v136, v137
    v_mfma_f32_16x16x32_bf16 v[124:127], v[168:171], v[60:63], v[124:127]
    v_pk_max_u16 v8, v138, v139
    v_pk_max_u16 v2, v2, v3
    v_pk_max_u16 v7, v7, v8
    ds_read_b128 v[40:43], v142 offset:6144
    ds_read_b128 v[76:79], v143 offset:6144
    s_waitcnt lgkmcnt(10)
    ds_write_b128 v144, v[112:115]
    ds_write_b128 v145, v[116:119]
    s_mov_b32 exec_hi, 0
    ds_write_b128 v148, v[128:131] offset:256
    s_mov_b64 exec, -1
    v_mfma_f32_16x16x32_bf16 v[120:123], v[172:175], v[28:31], v[120:123]
    v_pk_max_u16 v2, v2, v7
    v_lshlrev_b32 v3, 16, v2
    v_max_u32 v2, v2, v3
    v_mfma_f32_16x16x32_bf16 v[124:127], v[172:175], v[64:67], v[124:127]
    v_cmp_le_u32 vcc, 0xffff0000, v2
    v_lshlrev_b32 v96, 16, v132
    v_and_b32 v97, 0xffff0000, v132
    ds_read_b128 v[44:47], v142 offset:7168
    ds_read_b128 v[80:83], v143 offset:7168
    s_waitcnt lgkmcnt(9)
    v_mfma_f32_16x16x32_bf16 v[120:123], v[176:179], v[32:35], v[120:123]
    v_lshlrev_b32 v104, 16, v136
    v_and_b32 v105, 0xffff0000, v136
    s_cmp_eq_u64 vcc, 0
    s_cselect_b32 s54, 1, 0
    v_mfma_f32_16x16x32_bf16 v[124:127], v[176:179], v[68:71], v[124:127]
    v_lshlrev_b32 v98, 16, v133
    v_and_b32 v99, 0xffff0000, v133
    v_lshlrev_b32 v106, 16, v137
    ds_read_b128 v[48:51], v142 offset:8192
    ds_read_b128 v[84:87], v143 offset:8192
    s_setprio 0
    s_waitcnt lgkmcnt(9)
    v_mfma_f32_16x16x32_bf16 v[120:123], v[180:183], v[36:39], v[120:123]
    v_and_b32 v107, 0xffff0000, v137
    v_lshlrev_b32 v100, 16, v134
    v_and_b32 v101, 0xffff0000, v134
    v_mfma_f32_16x16x32_bf16 v[124:127], v[180:183], v[72:75], v[124:127]
    v_lshlrev_b32 v108, 16, v138
    v_and_b32 v109, 0xffff0000, v138
    v_lshlrev_b32 v102, 16, v135
    s_waitcnt lgkmcnt(7)
    v_mfma_f32_16x16x32_bf16 v[120:123], v[184:187], v[40:43], v[120:123]
    v_and_b32 v103, 0xffff0000, v135
    v_lshlrev_b32 v110, 16, v139
    v_and_b32 v111, 0xffff0000, v139
    v_mfma_f32_16x16x32_bf16 v[124:127], v[184:187], v[76:79], v[124:127]
    v_add_f32 v96, v96, v104
    v_add_f32 v97, v97, v105
    v_add_f32 v98, v98, v106
    v_add_f32 v99, v99, v107
    v_add_f32 v100, v100, v108
    v_add_f32 v101, v101, v109
    s_waitcnt lgkmcnt(2)
    v_mfma_f32_16x16x32_bf16 v[120:123], v[188:191], v[44:47], v[120:123]
    v_add_f32 v102, v102, v110
    v_add_f32 v103, v103, v111
    v_mul_f32 v96, v88, v96
    v_mul_f32 v97, v89, v97
    v_mul_f32 v98, v90, v98
    v_mul_f32 v99, v91, v99
    v_mfma_f32_16x16x32_bf16 v[124:127], v[188:191], v[80:83], v[124:127]
    v_mul_f32 v100, v92, v100
    v_mul_f32 v101, v93, v101
    v_mul_f32 v102, v94, v102
    v_mul_f32 v103, v95, v103
    v_cvt_pk_bf16_f32 v104, v96, v97
    s_waitcnt lgkmcnt(0)
    v_mfma_f32_16x16x32_bf16 v[120:123], v[192:195], v[48:51], v[120:123]
    v_cvt_pk_bf16_f32 v105, v98, v99
    v_cvt_pk_bf16_f32 v106, v100, v101
    v_cvt_pk_bf16_f32 v107, v102, v103
    v_mfma_f32_16x16x32_bf16 v[124:127], v[192:195], v[84:87], v[124:127]
    s_cmp_eq_u32 s54, 1
    s_cbranch_scc0 L_alate
    buffer_store_dwordx4 v[104:107], v255, s[60:63], 0 offen
L_alate:
    s_nop 1
    ds_write_b128 v146, v[120:123]
    s_nop 2
    ds_write_b128 v147, v[124:127]
    s_waitcnt lgkmcnt(0)
    s_barrier
    ds_read_b128 v[16:19], v152
    ds_read_b128 v[24:27], v152 offset:19456
    ds_read_b128 v[20:23], v152 offset:16
    ds_read_b128 v[28:31], v152 offset:19472
    s_waitcnt lgkmcnt(2)
    v_add_f32 v16, v16, v24
    v_add_f32 v17, v17, v25
    v_add_f32 v18, v18, v26
    v_add_f32 v19, v19, v27
    s_waitcnt lgkmcnt(0)
    v_add_f32 v20, v20, v28
    v_add_f32 v21, v21, v29
    v_add_f32 v22, v22, v30
    v_add_f32 v23, v23, v31
    v_cvt_pk_bf16_f32 v32, v16, v17
    v_cvt_pk_bf16_f32 v33, v18, v19
    v_cvt_pk_bf16_f32 v34, v20, v21
    v_cvt_pk_bf16_f32 v35, v22, v23
    buffer_store_dwordx4 v[32:35], v6, s[60:63], 0 offen offset:1152
    s_cmp_eq_u32 s3, 2
    s_cbranch_scc0 L_nob8
    v_mul_u32_u24 v3, 304, v1
    v_add_u32 v3, 256, v3
    ds_read_b128 v[16:19], v3
    ds_read_b128 v[24:27], v3 offset:19456
    ds_read_b128 v[20:23], v3 offset:16
    ds_read_b128 v[28:31], v3 offset:19472
    s_waitcnt lgkmcnt(2)
    v_add_f32 v16, v16, v24
    v_add_f32 v17, v17, v25
    v_add_f32 v18, v18, v26
    v_add_f32 v19, v19, v27
    s_waitcnt lgkmcnt(0)
    v_add_f32 v20, v20, v28
    v_add_f32 v21, v21, v29
    v_add_f32 v22, v22, v30
    v_add_f32 v23, v23, v31
    v_cvt_pk_bf16_f32 v32, v16, v17
    v_cvt_pk_bf16_f32 v33, v18, v19
    v_cvt_pk_bf16_f32 v34, v20, v21
    v_cvt_pk_bf16_f32 v35, v22, v23
    buffer_store_dwordx4 v[32:35], v15, s[60:63], 0 offen offset:1152
L_nob8:
    s_mov_b32 s83, 20000
    s_cmp_eq_u32 s54, 1
    s_cbranch_scc1 L_adone
L_aagain:
    s_mov_b32 m0, s22
    s_nop 0
    buffer_load_dwordx4 v149, s[68:71], s101 offen sc1 lds
    s_mov_b32 m0, s47
    s_mov_b64 exec, 0xffff
    buffer_load_dwordx4 v14, s[68:71], s81 offen sc1 lds
    s_mov_b64 exec, -1
    s_waitcnt vmcnt(0)
L_aget:
    ds_read_b64_tr_b16 v[132:133], v150
    ds_read_b64_tr_b16 v[134:135], v150 offset:128
    ds_read_b64_tr_b16 v[136:137], v151
    ds_read_b64_tr_b16 v[138:139], v151 offset:32
    s_waitcnt lgkmcnt(0)
    v_pk_max_u16 v2, v132, v133
    v_pk_max_u16 v3, v134, v135
    v_pk_max_u16 v7, v136, v137
    v_pk_max_u16 v8, v138, v139
    v_pk_max_u16 v2, v2, v3
    v_pk_max_u16 v7, v7, v8
    v_pk_max_u16 v2, v2, v7
    v_lshlrev_b32 v3, 16, v2
    v_max_u32 v2, v2, v3
    v_cmp_le_u32 vcc, 0xffff0000, v2
    v_lshlrev_b32 v96, 16, v132
    v_and_b32 v97, 0xffff0000, v132
    v_lshlrev_b32 v104, 16, v136
    v_and_b32 v105, 0xffff0000, v136
    s_cmp_eq_u64 vcc, 0
    s_cbranch_scc1 L_agot
    s_sub_u32 s83, s83, 1
    s_cmp_lg_u32 s83, 0
    s_cbranch_scc1 L_aagain
L_agot:
    v_lshlrev_b32 v98, 16, v133
    v_and_b32 v99, 0xffff0000, v133
    v_lshlrev_b32 v106, 16, v137
    v_and_b32 v107, 0xffff0000, v137
    v_lshlrev_b32 v100, 16, v134
    v_and_b32 v101, 0xffff0000, v134
    v_lshlrev_b32 v108, 16, v138
    v_and_b32 v109, 0xffff0000, v138
    v_lshlrev_b32 v102, 16, v135
    v_and_b32 v103, 0xffff0000, v135
    v_lshlrev_b32 v110, 16, v139
    v_and_b32 v111, 0xffff0000, v139
    v_add_f32 v96, v96, v104
    v_add_f32 v97, v97, v105
    v_add_f32 v98, v98, v106
    v_add_f32 v99, v99, v107
    v_add_f32 v100, v100, v108
    v_add_f32 v101, v101, v109
    v_add_f32 v102, v102, v110
    v_add_f32 v103, v103, v111
    v_mul_f32 v96, v88, v96
    v_mul_f32 v97, v89, v97
    v_mul_f32 v98, v90, v98
    v_mul_f32 v99, v91, v99
    v_mul_f32 v100, v92, v100
    v_mul_f32 v101, v93, v101
    v_mul_f32 v102, v94, v102
    v_mul_f32 v103, v95, v103
    v_cvt_pk_bf16_f32 v104, v96, v97
    v_cvt_pk_bf16_f32 v105, v98, v99
    v_cvt_pk_bf16_f32 v106, v100, v101
    v_cvt_pk_bf16_f32 v107, v102, v103
    buffer_store_dwordx4 v[104:107], v255, s[60:63], 0 offen
L_adone:
    s_cmp_eq_u32 s3, 3
    s_cbranch_scc0 L_fin
    s_cmp_eq_u32 s49, 0
    s_cbranch_scc0 L_fin
    s_mov_b32 s49, 1
    v_mov_b32 v149, v153
    s_mov_b32 s101, s37
    s_mov_b32 s81, s82
    s_mov_b32 s22, 143360
    s_mov_b32 s47, 146432
    v_add_u32 v150, 5120, v150
    v_lshlrev_b32 v2, 3, v11
    v_add_u32 v2, 146432, v2
    v_mov_b32 v9, 162304
    s_mov_b64 vcc, 0x1111
    v_mov_b32 v255, v15
    v_cndmask_b32 v151, v9, v2, vcc
    v_lshlrev_b32 v88, 16, v248
    v_and_b32 v89, 0xffff0000, v248
    v_lshlrev_b32 v90, 16, v249
    v_and_b32 v91, 0xffff0000, v249
    v_lshlrev_b32 v92, 16, v250
    v_and_b32 v93, 0xffff0000, v250
    v_lshlrev_b32 v94, 16, v251
    v_and_b32 v95, 0xffff0000, v251
    s_branch L_aget
L_fin:
L_end:
    s_endpgm
L_setup:
    s_mov_b32 s70, 16777216
    s_mov_b32 s71, 0x20000
    s_mov_b32 s66, 256
    s_mov_b32 s67, 0x20000
    s_mov_b32 s46, 663552
    s_mov_b32 s47, 0x20000
    s_mov_b32 s58, 663552
    s_mov_b32 s59, 0x20000
    s_mov_b32 s34, 2359296
    s_mov_b32 s35, 0x20000
    s_mov_b32 s38, 1152
    s_mov_b32 s39, 0x20000
    s_mov_b32 s62, 4718592
    s_mov_b32 s63, 0x20000
    s_mov_b32 s51, 0x20000
    s_mov_b32 s55, 0x20000
    s_mov_b32 s80, 0
    v_mov_b32 v212, 0
    s_mul_i32 s82, s5, 72
    s_lshr_b32 s6, s4, 2
    s_mul_i32 s6, s6, 9
    s_add_u32 s82, s82, s6
    s_and_b32 s6, s4, 3
    s_lshl_b32 s6, s6, 1
    s_add_u32 s81, s82, s6
    s_add_u32 s82, s82, 8
    s_cmp_lt_u32 s3, 4
    s_cselect_b32 s18, 0, 917504
    s_cselect_b32 s19, 0, 5120
    s_and_b32 s13, s3, 3
    s_lshr_b32 s12, s3, 2
    s_lshl_b32 s6, s13, 10
    s_add_u32 s18, s18, s6
    s_add_u32 s19, s19, s6
    s_add_u32 s19, s19, 128
    s_lshl_b32 s6, s81, 12
    s_add_u32 s16, s6, s18
    s_add_u32 s17, s16, 4096
    s_lshl_b32 s6, s82, 12
    s_add_u32 s18, s6, s18
    v_add_u32 v2, s81, v1
    v_writelane_b32 v2, s82, 2
    v_lshlrev_b32 v217, 12, v2
    v_lshlrev_b32 v216, 1, v2
    v_cmp_gt_u32 vcc, 3, v0
    v_mov_b32 v9, 0x80000000
    s_nop 0
    v_cndmask_b32 v217, v9, v217, vcc
    v_cndmask_b32 v216, v9, v216, vcc
    s_mul_i32 s21, s5, 92160
    s_mul_i32 s7, s12, 46080
    s_add_u32 s21, s21, s7
    s_add_u32 s21, s21, 163840
    s_mul_i32 s20, s13, 9216
    s_add_u32 s20, s20, s21
    s_add_u32 s21, s21, 36864
    s_mul_i32 s23, s3, 1008
    s_add_u32 s23, s23, 127264
    s_lshl_b32 s6, s4, 6
    s_lshl_b32 s7, s13, 4
    s_add_u32 s7, s7, s6
    v_and_b32 v2, 15, v1
    v_add_u32 v2, s7, v2
    v_mul_u32_u24 v3, 1152, v2
    s_mul_i32 s8, s5, 144
    s_lshl_b32 s7, s12, 6
    s_add_u32 s7, s7, s8
    v_lshl_add_u32 v2, v10, 4, s7
    v_add_u32 v238, v3, v2
    v_lshl_add_u32 v6, v3, 1, v2
    v_add_u32 v2, s6, v1
    v_mul_u32_u24 v3, 1152, v2
    s_add_u32 s9, s8, 128
    v_add_u32 v239, s9, v3
    v_lshl_add_u32 v15, v3, 1, s9
    v_mov_b32 v255, v6
    s_cmp_eq_u32 s3, 3
    s_cselect_b64 vcc, -1, 0
    v_cndmask_b32 v239, v9, v239, vcc
    v_lshlrev_b32 v240, 2, v1
    v_mul_u32_u24 v2, 7282, v1
    v_lshrrev_b32 v2, 16, v2
    v_mul_u32_u24 v2, 1008, v2
    v_lshlrev_b32 v7, 4, v1
    s_mul_i32 s7, s3, 7
    s_add_u32 s7, s7, s6
    s_mul_i32 s7, s7, 1152
    s_add_u32 s7, s7, s8
    v_add3_u32 v241, v2, v7, s7
    v_subrev_u32 v242, 3456, v241
    v_mov_b32 v13, 1
    v_add_u32 v5, 0x40000, v240
    v_mov_b32 v2, 163776
    v_cmp_eq_u32 vcc, 0, v1
    s_mul_i32 s10, s5, 576
    s_nop 0
    v_cndmask_b32 v5, v5, v2, vcc
    s_cmp_lt_u32 s3, 4
    s_cbranch_scc1 L_su_lo
    v_lshrrev_b32 v2, 3, v1
    v_mul_u32_u24 v2, 1152, v2
    v_and_b32 v7, 7, v1
    s_lshl_b32 s7, s13, 3
    v_add_u32 v7, s7, v7
    v_lshl_add_u32 v243, v7, 2, v2
    v_lshl_add_u32 v246, v7, 4, s10
    s_cmp_eq_u32 s78, 1
    s_cbranch_scc0 L_su_kv
    s_waitcnt vmcnt(0)
    s_and_b32 s6, s2, 63
    s_lshl_b32 s6, s6, 2
    v_mov_b32 v2, s6
    v_mov_b32 v3, 1
    s_mov_b64 exec, 1
    buffer_atomic_add v3, v2, s[64:67], 0 offen sc1
    s_mov_b64 exec, -1
    ds_add_u32 v5, v13 offset:4
    s_branch L_su_kv
L_su_lo:
    s_lshl_b32 s7, s3, 2
    s_add_u32 s7, s7, 128
    v_mul_u32_u24 v2, 144, v1
    v_add_u32 v243, s7, v2
    s_lshl_b32 s7, s3, 4
    s_add_u32 s7, s7, s10
    s_add_u32 s7, s7, 512
    v_mov_b32 v246, s7
    s_mul_i32 s22, s4, 3
    s_add_u32 s22, s22, s3
    s_cmp_eq_u32 s3, 3
    s_cselect_b32 s22, 99, s22
    s_mul_i32 s7, s22, 7282
    s_lshr_b32 s7, s7, 16
    s_mul_i32 s11, s7, 9
    s_sub_u32 s11, s22, s11
    s_cmp_ge_u32 s7, 5
    s_cselect_b32 s9, 1, 0
    s_mul_i32 s6, s9, 5
    s_sub_u32 s7, s7, s6
    s_mul_i32 s9, s9, 331776
    s_lshl_b32 s7, s7, 5
    s_add_u32 s9, s9, s7
    s_add_u32 s9, s9, s8
    v_bfe_u32 v2, v1, 1, 3
    v_lshrrev_b32 v3, 2, v2
    v_and_b32 v7, 3, v2
    v_lshl_add_u32 v3, v3, 3, v7
    s_lshr_b32 s6, s11, 1
    s_mul_i32 s6, s6, 18
    s_and_b32 s7, s11, 1
    s_lshl_b32 s7, s7, 2
    s_add_u32 s6, s6, s7
    v_add_u32 v3, s6, v3
    v_lshrrev_b32 v7, 1, v2
    v_mul_u32_u24 v7, 18, v7
    v_and_b32 v2, 1, v2
    v_add3_u32 v7, v7, v2, 16
    s_cmp_eq_u32 s11, 8
    s_cselect_b64 vcc, -1, 0
    v_cndmask_b32 v3, v3, v7, vcc
    v_mul_u32_u24 v7, 72, v10
    v_add_u32 v3, v3, v7
    v_mul_u32_u24 v3, 1152, v3
    v_and_b32 v2, 1, v1
    v_lshl_add_u32 v3, v2, 4, v3
    s_cmp_lt_u32 s22, 90
    s_cselect_b32 s9, s9, 0x40000000
    v_add_u32 v212, s9, v3
L_su_kv:
    v_add_u32 v244, 128416, v243
    v_add_u32 v245, 137360, v243
    v_add_u32 v243, 127264, v243
    v_lshlrev_b32 v14, 4, v1
    s_mul_i32 s6, s3, 3072
    s_add_u32 s6, s6, 36864
    s_xor_b32 s7, s3, 4
    s_mul_i32 s7, s7, 3072
    s_add_u32 s7, s7, 36864
    v_add_u32 v236, s6, v14
    v_add_u32 v237, s7, v14
    s_mul_i32 s6, s12, 9344
    v_lshlrev_b32 v2, 5, v12
    v_lshlrev_b32 v3, 6, v10
    v_sub_u32 v2, v2, v3
    v_lshlrev_b32 v7, 3, v11
    v_sub_u32 v2, v2, v7
    s_add_u32 s7, s6, 248
    v_add_u32 v232, s7, v2
    v_add_u32 v234, 18936, v2
    v_lshl_add_u32 v2, v12, 3, v3
    v_add_u32 v2, v2, v7
    s_lshl_b32 s8, s13, 7
    s_add_u32 s7, s6, s8
    s_add_u32 s7, s7, 4840
    v_add_u32 v233, s7, v2
    s_sub_u32 s30, 7, s13
    s_cmp_eq_u32 s12, 1
    s_cselect_b32 s30, s13, s30
    s_and_b32 s9, s4, 3
    s_lshl_b32 s7, s30, 9
    s_lshl_b32 s8, s9, 7
    s_add_u32 s7, s7, s8
    s_add_u32 s7, s7, 19944
    v_add_u32 v235, s7, v2
    s_add_u32 s6, s81, s12
    s_lshl_b32 s8, s6, 3
    s_lshl_b32 s6, s6, 12
    s_lshl_b32 s7, s13, 7
    s_add_u32 s6, s6, s7
    s_add_u32 s26, s6, 3276800
    s_mul_i32 s7, s13, 4608
    s_add_u32 s8, s8, s7
    s_add_u32 s27, s8, 8000000
    s_lshl_b32 s7, s30, 2
    s_add_u32 s7, s7, s9
    s_lshl_b32 s6, s82, 12
    s_lshl_b32 s8, s7, 7
    s_add_u32 s6, s6, s8
    s_add_u32 s28, s6, 3276800
    s_mul_i32 s7, s7, 4608
    s_lshl_b32 s8, s82, 3
    s_add_u32 s8, s8, s7
    s_add_u32 s29, s8, 8000000
    s_and_b32 s10, s3, 1
    s_bfe_u32 s11, s3, 0x10001
    s_lshl_b32 s11, s11, 1
    s_add_u32 s11, s11, s12
    s_lshl_b32 s6, s4, 2
    s_lshl_b32 s7, s10, 1
    s_add_u32 s6, s6, s7
    s_lshl_b32 s6, s6, 1
    s_lshr_b32 s7, s5, 2
    s_add_u32 s6, s6, s7
    s_mul_i32 s6, s6, 9216
    s_and_b32 s7, s5, 3
    s_lshl_b32 s7, s7, 8
    s_add_u32 s6, s6, s7
    s_add_u32 s6, s6, 5636096
    s_lshl_b32 s7, s11, 11
    s_add_u32 s24, s6, s7
    s_lshl_b32 s7, s11, 2
    s_add_u32 s6, s6, s7
    s_add_u32 s25, s6, 8192
    v_and_b32 v2, 15, v1
    v_lshlrev_b32 v2, 4, v2
    v_bfe_u32 v3, v1, 4, 1
    v_mul_u32_u24 v3, 18432, v3
    v_add_u32 v254, v2, v3
    v_lshrrev_b32 v3, 5, v1
    v_lshl_add_u32 v253, v3, 10, v254
    v_mov_b32 v248, -1
    v_mov_b32 v249, -1
    v_mov_b32 v250, -1
    v_mov_b32 v251, -1
    s_mul_i32 s6, s4, 73728
    s_mul_i32 s7, s5, 9216
    s_add_u32 s6, s6, s7
    s_add_u32 s6, s6, 5636096
    s_lshl_b32 s7, s3, 10
    s_add_u32 s31, s6, s7
    s_add_u32 s6, s6, 8192
    s_mul_i32 s8, s5, 294912
    s_lshl_b32 s7, s4, 7
    s_add_u32 s8, s8, s7
    s_add_u32 s8, s8, 3276800
    v_lshrrev_b32 v2, 3, v1
    v_lshlrev_b32 v2, 12, v2
    v_and_b32 v3, 7, v1
    v_lshl_add_u32 v2, v3, 4, v2
    s_lshl_b32 s7, s3, 15
    s_add_u32 s7, s7, s8
    v_add_u32 v206, s7, v2
    s_add_u32 s8, s8, 262144
    v_add_u32 v2, s8, v2
    s_mul_i32 s8, s4, 4608
    s_mul_i32 s7, s5, 576
    s_add_u32 s8, s8, s7
    s_add_u32 s8, s8, 7995392
    s_cmp_eq_u32 s3, 0
    s_cselect_b32 s6, s6, s8
    v_add_u32 v207, s6, v14
    s_cmp_eq_u32 s3, 1
    s_cselect_b64 vcc, -1, 0
    v_cndmask_b32 v207, v207, v2, vcc
    v_cmp_gt_u32 vcc, 164, v0
    s_nop 1
    v_cndmask_b32 v207, v9, v207, vcc
L_setup1:
    s_lshr_b32 s12, s3, 2
    s_mul_i32 s6, s12, 18432
    v_add_u32 v157, s6, v14
    v_and_b32 v2, 31, v1
    v_lshlrev_b32 v3, 4, v2
    s_add_u32 s7, s6, 8192
    v_add_u32 v158, s7, v3
    v_lshrrev_b32 v8, 5, v1
    v_mul_u32_u24 v7, 288, v8
    s_add_u32 s7, s6, 9216
    v_add3_u32 v159, v3, v7, s7
    s_mov_b32 s76, 0x3ffff
    s_mov_b32 s77, 0x3ffff
    v_mov_b32 v156, 0xdddddddd
    v_cmp_eq_u32 vcc, 18, v2
    v_mov_b32 v7, 0x3f803f80
    s_nop 0
    v_cndmask_b32 v7, 0, v7, vcc
    v_mov_b32 v140, v7
    v_mov_b32 v141, v7
    v_mov_b32 v142, v7
    v_mov_b32 v143, v7
    v_mov_b32 v144, v7
    v_mov_b32 v145, v7
    v_mov_b32 v146, v7
    v_mov_b32 v147, v7
    v_mov_b32 v148, v7
    v_mov_b32 v149, v7
    v_mov_b32 v150, v7
    v_mov_b32 v151, v7
    v_mov_b32 v152, v7
    v_mov_b32 v153, v7
    v_mov_b32 v154, v7
    v_mov_b32 v155, v7
    v_mov_b32 v80, 0
    v_mov_b32 v81, 0
    v_mov_b32 v82, 0
    v_mov_b32 v83, 0
    v_mov_b32 v84, 0
    v_mov_b32 v85, 0
    v_mov_b32 v86, 0
    v_mov_b32 v87, 0
    v_mov_b32 v88, 0
    v_mov_b32 v89, 0
    v_mov_b32 v90, 0
    v_mov_b32 v91, 0
    v_mov_b32 v92, 0
    v_mov_b32 v93, 0
    v_mov_b32 v94, 0
    v_mov_b32 v95, 0
    v_mov_b32 v96, 0
    v_mov_b32 v97, 0
    v_mov_b32 v98, 0
    v_mov_b32 v99, 0
    v_mov_b32 v100, 0
    v_mov_b32 v101, 0
    v_mov_b32 v102, 0
    v_mov_b32 v103, 0
    v_mov_b32 v104, 0
    v_mov_b32 v105, 0
    v_mov_b32 v106, 0
    v_mov_b32 v107, 0
    v_mov_b32 v108, 0
    v_mov_b32 v109, 0
    v_mov_b32 v110, 0
    v_mov_b32 v111, 0
    s_and_b32 s10, s3, 1
    s_bfe_u32 s11, s3, 0x10001
    s_lshl_b32 s6, s10, 5
    v_add_u32 v2, s6, v2
    v_mul_u32_u24 v2, 208, v2
    s_lshl_b32 s6, s11, 1
    s_add_u32 s7, s6, s12
    s_mul_i32 s7, s7, 48
    s_add_u32 s7, s7, 147456
    s_xor_b32 s8, s12, 1
    s_add_u32 s8, s8, s6
    s_mul_i32 s8, s8, 48
    s_add_u32 s8, s8, 147456
    v_lshl_add_u32 v3, v8, 4, v2
    v_add_u32 v112, s7, v3
    v_add_u32 v116, s8, v3
    v_xor_b32 v3, s12, v8
    v_add_u32 v3, s6, v3
    v_mul_u32_u24 v3, 48, v3
    v_add_u32 v3, v3, v2
    v_add_u32 v120, 147488, v3
    v_add_u32 v123, 147488, v3
    v_mov_b32 v121, 0
    v_mov_b32 v122, 0
    s_cmp_lg_u32 s80, 0
    s_cbranch_scc1 L_slowatt
    s_cmp_lt_u32 s3, 4
    s_cbranch_scc1 L_ret_q
    s_branch L_ret_k
L_sideB:
    s_mov_b32 s6, 0xffff0000
    s_mul_i32 s8, s5, 294912
    s_lshl_b32 s7, s4, 7
    s_add_u32 s8, s8, s7
    s_add_u32 s8, s8, 917504
    v_lshlrev_b32 v182, 16, v228
    v_lshlrev_b32 v183, 16, v230
    v_and_b32 v184, s6, v228
    v_and_b32 v185, s6, v230
    v_lshlrev_b32 v186, 16, v229
    v_lshlrev_b32 v187, 16, v231
    v_and_b32 v188, s6, v229
    v_and_b32 v189, s6, v231
    s_cmp_lt_u32 s3, 4
    s_cbranch_scc1 L_kvlo
    v_lshlrev_b32 v160, 16, v208
    v_and_b32 v161, s6, v208
    v_lshlrev_b32 v162, 16, v209
    v_and_b32 v163, s6, v209
    v_lshlrev_b32 v164, 16, v210
    v_and_b32 v165, s6, v210
    v_lshlrev_b32 v166, 16, v211
    v_and_b32 v167, s6, v211
    v_lshlrev_b32 v168, 16, v212
    v_and_b32 v169, s6, v212
    v_lshlrev_b32 v170, 16, v213
    v_and_b32 v171, s6, v213
    v_lshlrev_b32 v172, 16, v214
    v_and_b32 v173, s6, v214
    v_lshlrev_b32 v174, 16, v215
    v_and_b32 v175, s6, v215
    v_lshlrev_b32 v176, 16, v216
    v_and_b32 v177, s6, v216
    v_lshlrev_b32 v178, 16, v217
    v_and_b32 v179, s6, v217
    v_lshlrev_b32 v180, 16, v218
    v_and_b32 v181, s6, v218
    v_pk_mul_f32 v[190:191], v[160:161], v[188:189]
    v_pk_mul_f32 v[192:193], v[162:163], v[188:189]
    v_pk_mul_f32 v[194:195], v[164:165], v[188:189]
    v_pk_mul_f32 v[196:197], v[166:167], v[188:189]
    v_pk_mul_f32 v[198:199], v[168:169], v[188:189]
    v_pk_mul_f32 v[200:201], v[170:171], v[188:189]
    v_pk_mul_f32 v[202:203], v[172:173], v[188:189]
    v_pk_mul_f32 v[204:205], v[174:175], v[188:189]
    v_pk_fma_f32 v[190:191], v[162:163], v[186:187], v[190:191]
    v_pk_fma_f32 v[192:193], v[164:165], v[186:187], v[192:193]
    v_pk_fma_f32 v[194:195], v[166:167], v[186:187], v[194:195]
    v_pk_fma_f32 v[196:197], v[168:169], v[186:187], v[196:197]
    v_pk_fma_f32 v[198:199], v[170:171], v[186:187], v[198:199]
    v_pk_fma_f32 v[200:201], v[172:173], v[186:187], v[200:201]
    v_pk_fma_f32 v[202:203], v[174:175], v[186:187], v[202:203]
    v_pk_fma_f32 v[204:205], v[176:177], v[186:187], v[204:205]
    v_pk_fma_f32 v[190:191], v[164:165], v[184:185], v[190:191]
    v_pk_fma_f32 v[192:193], v[166:167], v[184:185], v[192:193]
    v_pk_fma_f32 v[194:195], v[168:169], v[184:185], v[194:195]
    v_pk_fma_f32 v[196:197], v[170:171], v[184:185], v[196:197]
    v_pk_fma_f32 v[198:199], v[172:173], v[184:185], v[198:199]
    v_pk_fma_f32 v[200:201], v[174:175], v[184:185], v[200:201]
    v_pk_fma_f32 v[202:203], v[176:177], v[184:185], v[202:203]
    v_pk_fma_f32 v[204:205], v[178:179], v[184:185], v[204:205]
    v_pk_fma_f32 v[190:191], v[166:167], v[182:183], v[190:191]
    v_pk_fma_f32 v[192:193], v[168:169], v[182:183], v[192:193]
    v_pk_fma_f32 v[194:195], v[170:171], v[182:183], v[194:195]
    v_pk_fma_f32 v[196:197], v[172:173], v[182:183], v[196:197]
    v_pk_fma_f32 v[198:199], v[174:175], v[182:183], v[198:199]
    v_pk_fma_f32 v[200:201], v[176:177], v[182:183], v[200:201]
    v_pk_fma_f32 v[202:203], v[178:179], v[182:183], v[202:203]
    v_pk_fma_f32 v[204:205], v[180:181], v[182:183], v[204:205]
    v_lshlrev_b32 v160, 16, v220
    v_and_b32 v161, s6, v220
    v_lshlrev_b32 v162, 16, v221
    v_and_b32 v163, s6, v221
    v_lshlrev_b32 v164, 16, v222
    v_and_b32 v165, s6, v222
    v_lshlrev_b32 v166, 16, v223
    v_and_b32 v167, s6, v223
    v_lshlrev_b32 v168, 16, v224
    v_and_b32 v169, s6, v224
    v_lshlrev_b32 v170, 16, v225
    v_and_b32 v171, s6, v225
    v_lshlrev_b32 v172, 16, v226
    v_and_b32 v173, s6, v226
    v_lshlrev_b32 v174, 16, v227
    v_and_b32 v175, s6, v227
    v_pk_mul_f32 v[190:191], v[190:191], v[160:161]
    v_pk_mul_f32 v[192:193], v[192:193], v[162:163]
    v_pk_mul_f32 v[194:195], v[194:195], v[164:165]
    v_pk_mul_f32 v[196:197], v[196:197], v[166:167]
    v_pk_mul_f32 v[198:199], v[198:199], v[168:169]
    v_pk_mul_f32 v[200:201], v[200:201], v[170:171]
    v_pk_mul_f32 v[202:203], v[202:203], v[172:173]
    v_pk_mul_f32 v[204:205], v[204:205], v[174:175]
    v_cvt_pk_bf16_f32 v160, v190, v192
    v_cvt_pk_bf16_f32 v161, v194, v196
    v_cvt_pk_bf16_f32 v162, v198, v200
    v_cvt_pk_bf16_f32 v163, v202, v204
    v_cvt_pk_bf16_f32 v164, v191, v193
    v_cvt_pk_bf16_f32 v165, v195, v197
    v_cvt_pk_bf16_f32 v166, v199, v201
    v_cvt_pk_bf16_f32 v167, v203, v205
    v_and_b32 v3, 7, v1
    v_lshrrev_b32 v2, 3, v1
    v_lshlrev_b32 v2, 4, v2
    v_lshl_add_u32 v2, v3, 13, v2
    s_sub_u32 s7, s3, 4
    s_lshl_b32 s7, s7, 16
    s_add_u32 s8, s8, s7
    s_add_u32 s7, s8, 4096
    buffer_store_dwordx4 v[160:163], v2, s[68:71], s8 offen sc1
    buffer_store_dwordx4 v[164:167], v2, s[68:71], s7 offen sc1
    s_branch L_sideBret
L_kvlo:
    v_lshlrev_b32 v160, 16, v208
    v_and_b32 v161, s6, v208
    v_lshlrev_b32 v162, 16, v209
    v_and_b32 v163, s6, v209
    v_lshlrev_b32 v164, 16, v210
    v_and_b32 v165, s6, v210
    v_lshlrev_b32 v166, 16, v211
    v_and_b32 v167, s6, v211
    v_lshlrev_b32 v168, 16, v220
    v_and_b32 v169, s6, v220
    v_pk_mul_f32 v[190:191], v[160:161], v[188:189]
    v_pk_fma_f32 v[190:191], v[162:163], v[186:187], v[190:191]
    v_pk_fma_f32 v[190:191], v[164:165], v[184:185], v[190:191]
    v_pk_fma_f32 v[190:191], v[166:167], v[182:183], v[190:191]
    v_pk_mul_f32 v[190:191], v[190:191], v[168:169]
    v_cvt_pk_bf16_f32 v190, v190, v191
    v_lshlrev_b32 v2, 1, v1
    s_lshl_b32 s7, s3, 13
    s_add_u32 s8, s8, s7
    s_add_u32 s8, s8, 262144
    s_add_u32 s7, s8, 4096
    buffer_store_short v190, v2, s[68:71], s8 offen sc1
    buffer_store_short_d16_hi v190, v2, s[68:71], s7 offen sc1
    v_lshlrev_b32 v2, 16, v216
    v_lshlrev_b32 v3, 16, v217
    v_add_f32 v2, v2, v3
    v_cvt_pk_bf16_f32 v252, v2, v2
    s_cmp_eq_u32 s78, 0
    s_cbranch_scc1 L_sideBret
    s_lshl_b32 s6, s3, 9
    s_add_u32 s6, s6, 160768
    v_and_b32 v3, 31, v1
    v_lshl_add_u32 v3, v3, 4, s6
    v_and_b32 v7, 1, v10
    v_lshl_add_u32 v2, v7, 3, v11
    v_lshlrev_b32 v2, 5, v2
    v_lshl_add_u32 v2, v12, 3, v2
    v_add_u32 v2, s6, v2
    s_mov_b32 exec_hi, 0
    ds_write_b128 v3, v[212:215]
    s_mov_b64 exec, -1
    ds_read_b64_tr_b16 v[160:161], v2
    ds_read_b64_tr_b16 v[162:163], v2 offset:128
    s_mov_b32 exec_lo, 0
    ds_write_b128 v3, v[212:215]
    s_mov_b64 exec, -1
    ds_read_b64_tr_b16 v[164:165], v2
    ds_read_b64_tr_b16 v[166:167], v2 offset:128
    s_waitcnt lgkmcnt(0)
    s_mov_b32 exec_hi, 0
    buffer_store_dwordx4 v[160:163], v14, s[68:71], s78 offen sc1
    s_mov_b32 exec_hi, -1
    s_mov_b32 exec_lo, 0
    buffer_store_dwordx4 v[164:167], v14, s[68:71], s78 offen sc1
    s_mov_b64 exec, -1
    s_branch L_sideBret
L_sideZ:
    s_cmp_lt_u32 s3, 3
    s_cbranch_scc0 L_sideZret
    s_mul_i32 s6, s3, 9344
    v_add_u32 v2, s6, v14
    v_add_u32 v3, 162304, v14
    v_mov_b32 v248, 0
    v_mov_b32 v249, 0
    v_mov_b32 v250, 0
    v_mov_b32 v251, 0
    ds_write_b128 v2, v[248:251] offset:4224
    s_mov_b64 exec, 0xff
    ds_write_b128 v2, v[248:251] offset:0
    ds_write_b128 v3, v[248:251]
    s_mov_b64 exec, -1
    s_branch L_sideZret
L_sideS:
    s_and_b32 s6, s2, 63
    s_lshl_b32 s6, s6, 2
    v_mov_b32 v2, s6
    v_mov_b32 v3, 65536
    s_mov_b64 exec, 1
    buffer_atomic_add v3, v2, s[64:67], 0 offen sc1
    s_mov_b64 exec, -1
    s_branch L_sideSret
L_sideK:
    s_cmp_lt_u32 s3, 2
    s_cbranch_scc0 L_sideK2
    v_add_u32 v2, 64512, v242
    s_add_u32 m0, s23, 8064
    s_nop 0
    buffer_load_dwordx4 v2, s[44:47], 0 offen nt lds
    s_branch L_sideKret
L_sideK2:
    v_add_u32 v2, 48384, v241
    s_add_u32 m0, s23, 16144
    s_nop 0
    buffer_load_dwordx4 v2, s[48:51], 0 offen nt lds
    s_branch L_sideKret
L_sideF:
    buffer_load_dword v4, v240, s[64:67], 0 offen sc1
    s_branch L_sideFret
L_sideG:
    v_bfe_u32 v3, v4, 16, 8
    v_cmp_ne_u32 vcc, 4, v3
    s_nop 0
    s_cmp_eq_u64 vcc, 0
    s_cbranch_scc1 L_sideGret
    v_lshlrev_b32 v2, 2, v1
    s_mov_b32 s83, 20000
L_poll_k:
    buffer_load_dword v3, v2, s[64:67], 0 offen sc1
    s_waitcnt vmcnt(0)
    v_bfe_u32 v3, v3, 16, 8
    v_cmp_ne_u32 vcc, 4, v3
    s_nop 0
    s_cmp_eq_u64 vcc, 0
    s_cbranch_scc1 L_polled_k
    s_sleep 8
    s_sub_u32 s83, s83, 1
    s_cmp_lg_u32 s83, 0
    s_cbranch_scc1 L_poll_k
L_polled_k:
    s_branch L_sideGret
L_cc_11s:
    v_mov_b32 v7, 163804
    s_mov_b32 s83, 200000
L_lw_12:
    ds_read_b32 v2, v7
    s_waitcnt lgkmcnt(0)
    v_readfirstlane_b32 s6, v2
    s_nop 0
    s_cmp_ge_u32 s6, 8
    s_cbranch_scc1 L_lw_12d
    s_sleep 1
    s_sub_u32 s83, s83, 1
    s_cmp_lg_u32 s83, 0
    s_cbranch_scc1 L_lw_12
L_lw_12d:
    s_branch L_cc_11
L_fo:
    v_mov_b32 v7, 163816
    s_mov_b32 s83, 200000
L_lw_13:
    ds_read_b32 v2, v7
    s_waitcnt lgkmcnt(0)
    v_readfirstlane_b32 s6, v2
    s_nop 0
    s_and_b32 s7, s6, 255
    s_cmp_ge_u32 s7, 8
    s_cbranch_scc1 L_lw_13d
    s_sleep 1
    s_sub_u32 s83, s83, 1
    s_cmp_lg_u32 s83, 0
    s_cbranch_scc1 L_lw_13
L_lw_13d:
    s_cmp_ge_u32 s6, 0x100
    s_cbranch_scc1 L_fallback
    v_add_u32 v7, s39, v14
    s_branch L_for
L_oagain:
    s_sub_u32 s83, s83, 1
    s_cmp_lg_u32 s83, 0
    s_cbranch_scc0 L_ogot
    s_add_u32 m0, s39, s52
    s_add_u32 s8, s100, s52
    buffer_load_dwordx4 v14, s[68:71], s8 offen sc1 lds
    s_add_u32 s52, s52, 1024
    s_cmp_eq_u32 s52, 9216
    s_cselect_b32 s52, 0, s52
    s_add_u32 m0, s39, s52
    s_add_u32 s8, s100, s52
    buffer_load_dwordx4 v14, s[68:71], s8 offen sc1 lds
    s_add_u32 s52, s52, 1024
    s_cmp_eq_u32 s52, 9216
    s_cselect_b32 s52, 0, s52
    s_add_u32 m0, s39, s52
    s_add_u32 s8, s100, s52
    buffer_load_dwordx4 v14, s[68:71], s8 offen sc1 lds
    s_add_u32 s52, s52, 1024
    s_cmp_eq_u32 s52, 9216
    s_cselect_b32 s52, 0, s52
    s_add_u32 m0, s39, s52
    s_add_u32 s8, s100, s52
    buffer_load_dwordx4 v14, s[68:71], s8 offen sc1 lds
    s_add_u32 s52, s52, 1024
    s_cmp_eq_u32 s52, 9216
    s_cselect_b32 s52, 0, s52
    s_add_u32 m0, s39, s52
    s_add_u32 s8, s100, s52
    buffer_load_dwordx4 v14, s[68:71], s8 offen sc1 lds
    s_add_u32 s52, s52, 1024
    s_cmp_eq_u32 s52, 9216
    s_cselect_b32 s52, 0, s52
    s_add_u32 m0, s39, s52
    s_add_u32 s8, s100, s52
    buffer_load_dwordx4 v14, s[68:71], s8 offen sc1 lds
    s_add_u32 s52, s52, 1024
    s_cmp_eq_u32 s52, 9216
    s_cselect_b32 s52, 0, s52
    s_add_u32 m0, s39, s52
    s_add_u32 s8, s100, s52
    buffer_load_dwordx4 v14, s[68:71], s8 offen sc1 lds
    s_add_u32 s52, s52, 1024
    s_cmp_eq_u32 s52, 9216
    s_cselect_b32 s52, 0, s52
    s_add_u32 m0, s39, s52
    s_add_u32 s8, s100, s52
    buffer_load_dwordx4 v14, s[68:71], s8 offen sc1 lds
    s_add_u32 s52, s52, 1024
    s_cmp_eq_u32 s52, 9216
    s_cselect_b32 s52, 0, s52
    s_add_u32 m0, s39, s52
    s_add_u32 s8, s100, s52
    buffer_load_dwordx4 v14, s[68:71], s8 offen sc1 lds
    s_add_u32 s52, s52, 1024
    s_cmp_eq_u32 s52, 9216
    s_cselect_b32 s52, 0, s52
    s_waitcnt vmcnt(0)
    s_branch L_ochk
L_x3:
    v_bfe_u32 v2, v1, 1, 3
    v_lshlrev_b32 v2, 12, v2
    v_lshl_add_u32 v2, v10, 5, v2
    v_add_u32 v153, v7, v2
    s_mov_b32 m0, 143360
    s_nop 0
    buffer_load_dwordx4 v153, s[68:71], s37 offen sc1 lds
    s_mov_b32 m0, 146432
    s_mov_b64 exec, 0xf
    buffer_load_dwordx4 v14, s[68:71], s82 offen sc1 lds
    s_mov_b64 exec, -1
    s_branch L_nox3
L_fallback:
    s_mov_b32 s80, 1
    s_waitcnt vmcnt(0) lgkmcnt(0)
    s_barrier
    v_mov_b32 v2, 0
    ds_write_b32 v5, v2 offset:40
    s_lshl_b32 s79, s3, 10
    s_add_u32 s79, s79, 0
    s_mov_b32 m0, s79
    s_nop 0
    buffer_load_dwordx4 v14, s[68:71], s79 offen sc1 lds
    s_add_u32 m0, m0, 8192
    s_add_u32 s79, s79, 8192
    buffer_load_dwordx4 v14, s[68:71], s79 offen sc1 lds
    s_add_u32 m0, m0, 8192
    s_add_u32 s79, s79, 8192
    buffer_load_dwordx4 v14, s[68:71], s79 offen sc1 lds
    s_add_u32 m0, m0, 8192
    s_add_u32 s79, s79, 8192
    buffer_load_dwordx4 v14, s[68:71], s79 offen sc1 lds
    s_add_u32 m0, m0, 8192
    s_add_u32 s79, s79, 8192
    buffer_load_dwordx4 v14, s[68:71], s79 offen sc1 lds
    s_add_u32 m0, m0, 8192
    s_add_u32 s79, s79, 8192
    buffer_load_dwordx4 v14, s[68:71], s79 offen sc1 lds
    s_add_u32 m0, m0, 8192
    s_add_u32 s79, s79, 8192
    buffer_load_dwordx4 v14, s[68:71], s79 offen sc1 lds
    s_add_u32 m0, m0, 8192
    s_add_u32 s79, s79, 8192
    buffer_load_dwordx4 v14, s[68:71], s79 offen sc1 lds
    s_add_u32 m0, m0, 8192
    s_add_u32 s79, s79, 8192
    buffer_load_dwordx4 v14, s[68:71], s79 offen sc1 lds
    s_add_u32 m0, m0, 8192
    s_add_u32 s79, s79, 8192
    buffer_load_dwordx4 v14, s[68:71], s79 offen sc1 lds
    s_add_u32 m0, m0, 8192
    s_add_u32 s79, s79, 8192
    buffer_load_dwordx4 v14, s[68:71], s79 offen sc1 lds
    s_add_u32 m0, m0, 8192
    s_add_u32 s79, s79, 8192
    buffer_load_dwordx4 v14, s[68:71], s79 offen sc1 lds
    s_add_u32 m0, m0, 8192
    s_add_u32 s79, s79, 8192
    buffer_load_dwordx4 v14, s[68:71], s79 offen sc1 lds
    s_add_u32 m0, m0, 8192
    s_add_u32 s79, s79, 8192
    buffer_load_dwordx4 v14, s[68:71], s79 offen sc1 lds
    s_add_u32 m0, m0, 8192
    s_add_u32 s79, s79, 8192
    buffer_load_dwordx4 v14, s[68:71], s79 offen sc1 lds
    s_add_u32 m0, m0, 8192
    s_add_u32 s79, s79, 8192
    buffer_load_dwordx4 v14, s[68:71], s79 offen sc1 lds
    s_add_u32 m0, m0, 8192
    s_add_u32 s79, s79, 8192
    buffer_load_dwordx4 v14, s[68:71], s79 offen sc1 lds
    s_add_u32 m0, m0, 8192
    s_add_u32 s79, s79, 8192
    buffer_load_dwordx4 v14, s[68:71], s79 offen sc1 lds
    s_branch L_setup1
L_slowatt:
    ds_read_b128 v[112:115], v112
    ds_read_b128 v[116:119], v116
    ds_read_b32 v120, v120
    ds_read_b32 v123, v123
    s_waitcnt vmcnt(0) lgkmcnt(0)
    s_barrier
    v_mov_b32 v48, 0xff800000
    v_mov_b32 v49, 0xff800000
    v_mov_b32 v133, 0
    v_mov_b32 v7, v157
    v_mov_b32 v8, v159
    v_mov_b32 v9, v158
    s_mov_b32 s78, 0
L_maxloop:
    ds_read_b32 v132, v9
    ds_read_b128 v[124:127], v7
    s_mov_b64 exec, s[76:77]
    ds_read_b128 v[140:143], v8
    ds_read_b128 v[144:147], v8 offset:576
    s_mov_b64 exec, -1
    s_waitcnt lgkmcnt(0)
    v_mfma_f32_32x32x4_2b_bf16 v[16:47], v[132:133], v[120:121], 0
    s_nop 1
    s_nop 15
    v_mfma_f32_32x32x16_bf16 v[16:31], v[124:127], v[112:115], v[16:31]
    v_mfma_f32_32x32x16_bf16 v[32:47], v[124:127], v[116:119], v[32:47]
    s_nop 10
    v_max3_f32 v48, v48, v16, v17
    v_max3_f32 v49, v49, v32, v33
    v_max3_f32 v48, v48, v18, v19
    v_max3_f32 v49, v49, v34, v35
    v_max3_f32 v48, v48, v20, v21
    v_max3_f32 v49, v49, v36, v37
    v_max3_f32 v48, v48, v22, v23
    v_max3_f32 v49, v49, v38, v39
    v_max3_f32 v48, v48, v24, v25
    v_max3_f32 v49, v49, v40, v41
    v_max3_f32 v48, v48, v26, v27
    v_max3_f32 v49, v49, v42, v43
    v_max3_f32 v48, v48, v28, v29
    v_max3_f32 v49, v49, v44, v45
    v_max3_f32 v48, v48, v30, v31
    v_max3_f32 v49, v49, v46, v47
    s_add_u32 s78, s78, 1
    s_and_b32 s6, s78, 3
    s_cmp_eq_u32 s6, 0
    s_cselect_b32 s6, 500, 4
    s_and_b32 s7, s78, 7
    s_cmp_eq_u32 s7, 0
    s_cselect_b32 s7, 28672, 0
    s_cselect_b32 s8, 27648, 0
    s_cselect_b32 s9, 35840, 0
    s_add_u32 s7, s7, 1024
    s_add_u32 s8, s8, 1152
    s_add_u32 s6, s6, s9
    v_add_u32 v7, s7, v7
    v_add_u32 v8, s8, v8
    v_add_u32 v9, s6, v9
    s_cmp_lt_u32 s78, 32
    s_cbranch_scc1 L_maxloop
    v_mov_b32 v50, v48
    v_mov_b32 v51, v49
    s_nop 0
    v_permlane32_swap_b32 v48, v50
    v_permlane32_swap_b32 v49, v51
    v_max_f32 v48, v48, v50
    v_max_f32 v49, v49, v51
    s_lshl_b32 s6, s3, 9
    s_add_u32 s6, s6, 147456
    s_xor_b32 s7, s3, 4
    s_lshl_b32 s7, s7, 9
    s_add_u32 s7, s7, 147456
    v_lshl_add_u32 v3, v1, 3, s6
    v_lshl_add_u32 v7, v1, 3, s7
    ds_write_b64 v3, v[48:49]
    s_waitcnt lgkmcnt(0)
    s_barrier
    ds_read_b64 v[50:51], v7
    s_waitcnt lgkmcnt(0)
    v_max_f32 v48, v48, v51
    v_max_f32 v49, v49, v50
    v_mov_b32 v7, v157
    v_mov_b32 v8, v159
    v_mov_b32 v9, v158
    s_mov_b32 s78, 0
L_slowloop:
    ds_read_b32 v132, v9
    ds_read_b128 v[124:127], v7
    s_mov_b64 exec, s[76:77]
    ds_read_b128 v[140:143], v8
    ds_read_b128 v[144:147], v8 offset:576
    s_mov_b64 exec, -1
    s_waitcnt lgkmcnt(0)
    v_mfma_f32_32x32x4_2b_bf16 v[16:47], v[132:133], v[120:121], 0
    s_nop 1
    s_nop 15
    v_mfma_f32_32x32x16_bf16 v[16:31], v[124:127], v[112:115], v[16:31]
    v_mfma_f32_32x32x16_bf16 v[32:47], v[124:127], v[116:119], v[32:47]
    s_nop 10
    v_sub_f32 v16, v16, v48
    v_sub_f32 v17, v17, v48
    v_sub_f32 v18, v18, v48
    v_sub_f32 v19, v19, v48
    v_sub_f32 v20, v20, v48
    v_sub_f32 v21, v21, v48
    v_sub_f32 v22, v22, v48
    v_sub_f32 v23, v23, v48
    v_sub_f32 v24, v24, v48
    v_sub_f32 v25, v25, v48
    v_sub_f32 v26, v26, v48
    v_sub_f32 v27, v27, v48
    v_sub_f32 v28, v28, v48
    v_sub_f32 v29, v29, v48
    v_sub_f32 v30, v30, v48
    v_sub_f32 v31, v31, v48
    v_sub_f32 v32, v32, v49
    v_sub_f32 v33, v33, v49
    v_sub_f32 v34, v34, v49
    v_sub_f32 v35, v35, v49
    v_sub_f32 v36, v36, v49
    v_sub_f32 v37, v37, v49
    v_sub_f32 v38, v38, v49
    v_sub_f32 v39, v39, v49
    v_sub_f32 v40, v40, v49
    v_sub_f32 v41, v41, v49
    v_sub_f32 v42, v42, v49
    v_sub_f32 v43, v43, v49
    v_sub_f32 v44, v44, v49
    v_sub_f32 v45, v45, v49
    v_sub_f32 v46, v46, v49
    v_sub_f32 v47, v47, v49
    v_exp_f32 v16, v16
    v_exp_f32 v17, v17
    v_exp_f32 v18, v18
    v_exp_f32 v19, v19
    v_exp_f32 v20, v20
    v_exp_f32 v21, v21
    v_exp_f32 v22, v22
    v_exp_f32 v23, v23
    v_exp_f32 v24, v24
    v_exp_f32 v25, v25
    v_exp_f32 v26, v26
    v_exp_f32 v27, v27
    v_exp_f32 v28, v28
    v_exp_f32 v29, v29
    v_exp_f32 v30, v30
    v_exp_f32 v31, v31
    v_exp_f32 v32, v32
    v_exp_f32 v33, v33
    v_exp_f32 v34, v34
    v_exp_f32 v35, v35
    v_exp_f32 v36, v36
    v_exp_f32 v37, v37
    v_exp_f32 v38, v38
    v_exp_f32 v39, v39
    v_exp_f32 v40, v40
    v_exp_f32 v41, v41
    v_exp_f32 v42, v42
    v_exp_f32 v43, v43
    v_exp_f32 v44, v44
    v_exp_f32 v45, v45
    v_exp_f32 v46, v46
    v_exp_f32 v47, v47
    v_smfmac_f32_32x32x32_bf16 v[80:95], v[140:143], v[16:23], v156
    v_smfmac_f32_32x32x32_bf16 v[80:95], v[144:147], v[24:31], v156
    v_smfmac_f32_32x32x32_bf16 v[96:111], v[140:143], v[32:39], v156
    v_smfmac_f32_32x32x32_bf16 v[96:111], v[144:147], v[40:47], v156
    s_add_u32 s78, s78, 1
    s_and_b32 s6, s78, 3
    s_cmp_eq_u32 s6, 0
    s_cselect_b32 s6, 500, 4
    s_and_b32 s7, s78, 7
    s_cmp_eq_u32 s7, 0
    s_cselect_b32 s7, 28672, 0
    s_cselect_b32 s8, 27648, 0
    s_cselect_b32 s9, 35840, 0
    s_add_u32 s7, s7, 1024
    s_add_u32 s8, s8, 1152
    s_add_u32 s6, s6, s9
    v_add_u32 v7, s7, v7
    v_add_u32 v8, s8, v8
    v_add_u32 v9, s6, v9
    s_cmp_lt_u32 s78, 32
    s_cbranch_scc1 L_slowloop
    s_barrier
    s_cmp_lt_u32 s3, 3
    s_cbranch_scc0 L_nz2
    s_mul_i32 s6, s3, 9344
    v_add_u32 v2, s6, v14
    v_add_u32 v3, 162304, v14
    v_mov_b32 v248, 0
    v_mov_b32 v249, 0
    v_mov_b32 v250, 0
    v_mov_b32 v251, 0
    ds_write_b128 v2, v[248:251] offset:4224
    s_mov_b64 exec, 0xff
    ds_write_b128 v2, v[248:251] offset:0
    ds_write_b128 v3, v[248:251]
    s_mov_b64 exec, -1
L_nz2:
    s_add_u32 m0, s19, 0
    s_nop 0
    buffer_load_dwordx4 v14, s[72:75], s16 offen sc1 lds
    s_add_u32 m0, s19, 9344
    s_nop 0
    buffer_load_dwordx4 v14, s[72:75], s17 offen sc1 lds
    s_add_u32 m0, s19, 18688
    s_nop 0
    buffer_load_dwordx4 v14, s[72:75], s18 offen sc1 lds
    s_waitcnt vmcnt(0)
    s_branch L_attdone
L_codeend:
    s_endpgm
.section .rodata,"a"
.p2align 6
.amdhsa_kernel concat_heads__ssm_conv_h3__grouped_kv_mqa__prompt_kernel
  .amdhsa_next_free_vgpr 256
  .amdhsa_next_free_sgpr 102
  .amdhsa_accum_offset 256
  .amdhsa_group_segment_fixed_size 0
  .amdhsa_kernarg_size 112
  .amdhsa_user_sgpr_count 2
  .amdhsa_user_sgpr_kernarg_segment_ptr 1
  .amdhsa_system_sgpr_workgroup_id_x 1
.end_amdhsa_kernel
```
